```python
import torch

def _softmax(x, axis=-1):
    return torch.softmax(x, dim=axis)
def _gelu(x):
    return torch.nn.functional.gelu(x, approximate="tanh")
def _silu(x):
    return torch.nn.functional.silu(x)
def _sigmoid(x):
    return torch.sigmoid(x)
def _layernorm(x, axis=-1, eps=1e-5):
    m = x.mean(dim=axis, keepdim=True)
    v = x.var(dim=axis, keepdim=True, unbiased=False)
    return (x - m) / torch.sqrt(v + eps)
def _scatter_add(tgt, idx, src, axis=0):
    return tgt.clone().index_add_(axis, idx, src)
def _segment_sum(src, seg, n):
    out = torch.zeros((n,) + src.shape[1:], dtype=src.dtype)
    return out.index_add_(0, seg, src)
def _pad(x, pw):
    flat = tuple(v for pair in reversed(pw) for v in pair)
    return torch.nn.functional.pad(x, flat)

kernel_name = 'gather_scatter__edge_featured_mpnn_gatedgcn__graph'

def setup_inputs():

    _w = (lambda a: (lambda t: t.to(torch.bfloat16) if t.is_floating_point() else t)(torch.as_tensor(a)))
    N, deg, D, De = 50000, 16, 64, max(0, 1)
    E = N * deg
    return {
        "x": _w((lambda *s: torch.randn(*s, dtype=torch.bfloat16) * 0.4)(N, D)),
        "e_attr": _w((lambda *s: torch.randn(*s, dtype=torch.bfloat16) * 0.8)(E, De)),
        "src": _w((lambda lo, hi, *s: torch.randint(lo, hi, s))(0, N, E).to(torch.int64)),
        "dst": _w((lambda lo, hi, *s: torch.randint(lo, hi, s))(0, N, E).to(torch.int64)),
        "w_a": _w((lambda *s: torch.randn(*s, dtype=torch.bfloat16) * 0.8)(D, D)),
        "w_b": _w((lambda *s: torch.randn(*s, dtype=torch.bfloat16) * 0.4)(D, D)),
        "w_c": _w((lambda *s: torch.randn(*s, dtype=torch.bfloat16) * 0.8)(De, D)),
        "w_u": _w((lambda *s: torch.randn(*s, dtype=torch.bfloat16) * 0.05)(D, D)),
        "w_v": _w((lambda *s: torch.randn(*s, dtype=torch.bfloat16) * 0.05)(D, D)),
    }

def reference(x, e_attr, src, dst, w_a, w_b, w_c, w_u, w_v):
    N, D = x.shape
    hv = x @ w_v
    g = x[dst] @ w_a + x[src] @ w_b + e_attr @ w_c
    eta = _sigmoid(g)
    denom = _segment_sum(eta, dst, N) + 1e-6
    eta_n = eta / denom[dst]
    agg = _segment_sum(eta_n * hv[src], dst, N)
    z = x @ w_u + agg
    relu_z = torch.where(z > 0, z, 0 * z)
    return x + relu_z
```

```asm
; @launch kernel=part_kernel grid=(255,1,1) block=(832,1,1) lds=44288
; @launch kernel=main_kernel grid=(256,1,1) block=(512,1,1) lds=160576
.amdgcn_target "amdgcn-amd-amdhsa--gfx950"
.text
.globl part_kernel
.p2align 8
.type part_kernel,@function
part_kernel:
    s_cmp_ge_u32 s2, 250
    s_cbranch_scc1 K1_W
    s_load_dwordx2 s[8:9], s[0:1], 24
    s_load_dwordx4 s[4:7], s[0:1], 8
    s_load_dwordx2 s[10:11], s[0:1], 88
    s_load_dwordx2 s[22:23], s[0:1], 0
    v_cmp_gt_u32 vcc, 800, v0
    s_mul_i32 s12, s2, 12800
    v_lshlrev_b32 v1, 4, v0
    v_add_u32 v2, s12, v1
    v_lshrrev_b32 v3, 1, v2
    v_lshlrev_b32 v4, 2, v0
    v_mov_b32 v40, 0
    v_mov_b32 v41, 0
    v_mov_b32 v42, 0
    v_mov_b32 v43, 0
    v_mov_b32 v6, 1
    s_mov_b64 s[20:21], vcc
    s_mov_b64 exec, vcc
    s_waitcnt lgkmcnt(0)
    global_load_dwordx4 v[8:11], v2, s[8:9] nt
    global_load_dwordx4 v[12:15], v2, s[6:7] nt
    global_load_dwordx2 v[16:17], v3, s[4:5] nt
    s_mov_b64 exec, -1
    ds_write_b32 v4, v40 offset:40960
    ds_write_b128 v1, v[40:43]
    ds_write_b128 v1, v[40:43] offset:13312
    ds_write_b128 v1, v[40:43] offset:26624
    s_movk_i32 s13, -196
    s_mov_b32 s14, 0xffff0000
    s_mov_b64 exec, s[20:21]
    s_waitcnt lgkmcnt(0)
    s_barrier
    s_waitcnt vmcnt(2)
    v_mul_u32_u24 v20, 0x14e5f, v8
    v_lshrrev_b32 v20, 24, v20
    v_lshlrev_b32 v24, 2, v20
    ds_add_rtn_u32 v28, v24, v6 offset:40960
    v_mul_u32_u24 v21, 0x14e5f, v9
    v_lshrrev_b32 v21, 24, v21
    v_lshlrev_b32 v25, 2, v21
    ds_add_rtn_u32 v29, v25, v6 offset:40960
    v_mul_u32_u24 v22, 0x14e5f, v10
    v_lshrrev_b32 v22, 24, v22
    v_lshlrev_b32 v26, 2, v22
    ds_add_rtn_u32 v30, v26, v6 offset:40960
    v_mul_u32_u24 v23, 0x14e5f, v11
    v_lshrrev_b32 v23, 24, v23
    v_lshlrev_b32 v27, 2, v23
    ds_add_rtn_u32 v31, v27, v6 offset:40960
    v_mad_i32_i24 v8, v20, s13, v8
    v_add_u32 v8, 1, v8
    v_mad_i32_i24 v9, v21, s13, v9
    v_add_u32 v9, 1, v9
    v_mad_i32_i24 v10, v22, s13, v10
    v_add_u32 v10, 1, v10
    v_mad_i32_i24 v11, v23, s13, v11
    v_add_u32 v11, 1, v11
    s_waitcnt vmcnt(0)
    v_lshl_or_b32 v32, v16, 16, v12
    v_and_or_b32 v33, v16, s14, v13
    v_lshl_or_b32 v34, v17, 16, v14
    v_and_or_b32 v35, v17, s14, v15
    s_waitcnt lgkmcnt(0)
    v_max3_u32 v36, v28, v29, v30
    v_max_u32 v36, v36, v31
    v_cmp_lt_u32 vcc, 23, v36
    s_cbranch_vccnz K1_OVF
    v_and_b32 v36, 7, v28
    v_lshl_add_u32 v36, v24, 1, v36
    v_lshrrev_b32 v37, 3, v28
    v_lshlrev_b32 v36, 4, v36
    v_lshl_add_u32 v38, v37, 2, v36
    v_add_u32 v39, v37, v36
    ds_write_b32 v38, v32
    ds_write_b8 v39, v8 offset:12
    v_and_b32 v36, 7, v29
    v_lshl_add_u32 v36, v25, 1, v36
    v_lshrrev_b32 v37, 3, v29
    v_lshlrev_b32 v36, 4, v36
    v_lshl_add_u32 v38, v37, 2, v36
    v_add_u32 v39, v37, v36
    ds_write_b32 v38, v33
    ds_write_b8 v39, v9 offset:12
    v_and_b32 v36, 7, v30
    v_lshl_add_u32 v36, v26, 1, v36
    v_lshrrev_b32 v37, 3, v30
    v_lshlrev_b32 v36, 4, v36
    v_lshl_add_u32 v38, v37, 2, v36
    v_add_u32 v39, v37, v36
    ds_write_b32 v38, v34
    ds_write_b8 v39, v10 offset:12
    v_and_b32 v36, 7, v31
    v_lshl_add_u32 v36, v27, 1, v36
    v_lshrrev_b32 v37, 3, v31
    v_lshlrev_b32 v36, 4, v36
    v_lshl_add_u32 v38, v37, 2, v36
    v_add_u32 v39, v37, v36
    ds_write_b32 v38, v35
    ds_write_b8 v39, v11 offset:12
K1_PUTDONE:
    s_mov_b64 exec, -1
    s_lshl_b32 s12, s2, 15
    v_add_u32 v2, s12, v1
    v_add_u32 v3, 13312, v2
    v_add_u32 v5, 26624, v2
    v_cmp_gt_u32 vcc, 384, v0
    v_mov_b32 v7, 41984
    s_waitcnt lgkmcnt(0)
    s_barrier
    ds_read_b128 v[8:11], v1
    ds_read_b128 v[12:15], v1 offset:13312
    ds_read_b128 v[16:19], v1 offset:26624
    ds_read_b32 v20, v7
    s_waitcnt lgkmcnt(3)
    global_store_dwordx4 v2, v[8:11], s[10:11] sc1
    s_waitcnt lgkmcnt(2)
    global_store_dwordx4 v3, v[12:15], s[10:11] sc1
    s_and_b64 exec, exec, vcc
    s_waitcnt lgkmcnt(0)
    global_store_dwordx4 v5, v[16:19], s[10:11] sc1
    s_mov_b64 exec, -1
    s_mul_i32 s12, s2, 25728
    s_add_u32 s12, s12, 10747904
    v_cmp_eq_u32 vcc, 831, v0
    v_mov_b32 v7, s12
    s_and_b64 exec, exec, vcc
    global_store_dword v7, v20, s[10:11]
    s_endpgm
K1_OVF:
    s_mul_i32 s12, s2, 25728
    s_add_u32 s12, s12, 10747920
    s_lshl_b32 s15, s2, 13
    s_add_u32 s15, s15, 8650752
    v_mov_b32 v7, 41984
    s_mov_b64 exec, s[20:21]
    v_cmp_lt_u32 vcc, 23, v28
    v_cmp_lt_u32 s[16:17], 31, v28
    s_andn2_b64 exec, exec, vcc
    v_and_b32 v36, 7, v28
    v_lshl_add_u32 v36, v24, 1, v36
    v_lshrrev_b32 v37, 3, v28
    v_lshlrev_b32 v36, 4, v36
    v_lshl_add_u32 v38, v37, 2, v36
    v_add_u32 v39, v37, v36
    ds_write_b32 v38, v32
    ds_write_b8 v39, v8 offset:12
    s_andn2_b64 exec, vcc, s[16:17]
    s_cbranch_execz K1_OVM0
    v_and_b32 v36, 7, v28
    v_lshl_add_u32 v36, v24, 1, v36
    v_lshlrev_b32 v37, 4, v36
    v_lshl_add_u32 v36, v36, 2, s15
    ds_write_b8 v37, v8 offset:15
    global_store_dword v36, v32, s[10:11]
K1_OVM0:
    s_mov_b64 exec, s[16:17]
    s_cbranch_execz K1_OVN0
    ds_add_rtn_u32 v36, v7, v6
    v_mov_b32 v46, v32
    v_lshlrev_b32 v47, 2, v8
    v_lshl_or_b32 v47, v20, 16, v47
    s_waitcnt lgkmcnt(0)
    v_lshl_add_u32 v36, v36, 3, s12
    global_store_dwordx2 v36, v[46:47], s[10:11]
K1_OVN0:
    s_mov_b64 exec, s[20:21]
    v_cmp_lt_u32 vcc, 23, v29
    v_cmp_lt_u32 s[16:17], 31, v29
    s_andn2_b64 exec, exec, vcc
    v_and_b32 v36, 7, v29
    v_lshl_add_u32 v36, v25, 1, v36
    v_lshrrev_b32 v37, 3, v29
    v_lshlrev_b32 v36, 4, v36
    v_lshl_add_u32 v38, v37, 2, v36
    v_add_u32 v39, v37, v36
    ds_write_b32 v38, v33
    ds_write_b8 v39, v9 offset:12
    s_andn2_b64 exec, vcc, s[16:17]
    s_cbranch_execz K1_OVM1
    v_and_b32 v36, 7, v29
    v_lshl_add_u32 v36, v25, 1, v36
    v_lshlrev_b32 v37, 4, v36
    v_lshl_add_u32 v36, v36, 2, s15
    ds_write_b8 v37, v9 offset:15
    global_store_dword v36, v33, s[10:11]
K1_OVM1:
    s_mov_b64 exec, s[16:17]
    s_cbranch_execz K1_OVN1
    ds_add_rtn_u32 v36, v7, v6
    v_mov_b32 v46, v33
    v_lshlrev_b32 v47, 2, v9
    v_lshl_or_b32 v47, v21, 16, v47
    s_waitcnt lgkmcnt(0)
    v_lshl_add_u32 v36, v36, 3, s12
    global_store_dwordx2 v36, v[46:47], s[10:11]
K1_OVN1:
    s_mov_b64 exec, s[20:21]
    v_cmp_lt_u32 vcc, 23, v30
    v_cmp_lt_u32 s[16:17], 31, v30
    s_andn2_b64 exec, exec, vcc
    v_and_b32 v36, 7, v30
    v_lshl_add_u32 v36, v26, 1, v36
    v_lshrrev_b32 v37, 3, v30
    v_lshlrev_b32 v36, 4, v36
    v_lshl_add_u32 v38, v37, 2, v36
    v_add_u32 v39, v37, v36
    ds_write_b32 v38, v34
    ds_write_b8 v39, v10 offset:12
    s_andn2_b64 exec, vcc, s[16:17]
    s_cbranch_execz K1_OVM2
    v_and_b32 v36, 7, v30
    v_lshl_add_u32 v36, v26, 1, v36
    v_lshlrev_b32 v37, 4, v36
    v_lshl_add_u32 v36, v36, 2, s15
    ds_write_b8 v37, v10 offset:15
    global_store_dword v36, v34, s[10:11]
K1_OVM2:
    s_mov_b64 exec, s[16:17]
    s_cbranch_execz K1_OVN2
    ds_add_rtn_u32 v36, v7, v6
    v_mov_b32 v46, v34
    v_lshlrev_b32 v47, 2, v10
    v_lshl_or_b32 v47, v22, 16, v47
    s_waitcnt lgkmcnt(0)
    v_lshl_add_u32 v36, v36, 3, s12
    global_store_dwordx2 v36, v[46:47], s[10:11]
K1_OVN2:
    s_mov_b64 exec, s[20:21]
    v_cmp_lt_u32 vcc, 23, v31
    v_cmp_lt_u32 s[16:17], 31, v31
    s_andn2_b64 exec, exec, vcc
    v_and_b32 v36, 7, v31
    v_lshl_add_u32 v36, v27, 1, v36
    v_lshrrev_b32 v37, 3, v31
    v_lshlrev_b32 v36, 4, v36
    v_lshl_add_u32 v38, v37, 2, v36
    v_add_u32 v39, v37, v36
    ds_write_b32 v38, v35
    ds_write_b8 v39, v11 offset:12
    s_andn2_b64 exec, vcc, s[16:17]
    s_cbranch_execz K1_OVM3
    v_and_b32 v36, 7, v31
    v_lshl_add_u32 v36, v27, 1, v36
    v_lshlrev_b32 v37, 4, v36
    v_lshl_add_u32 v36, v36, 2, s15
    ds_write_b8 v37, v11 offset:15
    global_store_dword v36, v35, s[10:11]
K1_OVM3:
    s_mov_b64 exec, s[16:17]
    s_cbranch_execz K1_OVN3
    ds_add_rtn_u32 v36, v7, v6
    v_mov_b32 v46, v35
    v_lshlrev_b32 v47, 2, v11
    v_lshl_or_b32 v47, v23, 16, v47
    s_waitcnt lgkmcnt(0)
    v_lshl_add_u32 v36, v36, 3, s12
    global_store_dwordx2 v36, v[46:47], s[10:11]
K1_OVN3:
    s_branch K1_PUTDONE
K1_W:
    s_cmp_ge_u32 s2, 255
    s_cbranch_scc1 K1_END
    s_load_dwordx8 s[4:11], s[0:1], 32
    s_load_dwordx2 s[12:13], s[0:1], 64
    s_load_dwordx2 s[14:15], s[0:1], 88
    s_sub_u32 s3, s2, 250
    v_bfe_u32 v1, v0, 2, 1
    v_lshlrev_b32 v1, 5, v1
    v_and_b32 v2, 3, v0
    v_add_u32 v1, v1, v2
    v_bfe_u32 v2, v0, 3, 2
    v_lshl_add_u32 v1, v2, 2, v1
    s_cmp_eq_u32 s3, 4
    s_cbranch_scc1 K1_WC
    v_cmp_gt_u32 vcc, 512, v0
    s_and_b64 exec, exec, vcc
    s_cbranch_execz K1_END
    v_bfe_u32 v2, v0, 8, 1
    v_lshl_add_u32 v1, v2, 4, v1
    v_lshlrev_b32 v1, 1, v1
    v_bfe_u32 v2, v0, 5, 1
    v_lshl_add_u32 v1, v2, 12, v1
    v_bfe_u32 v2, v0, 6, 2
    v_lshl_add_u32 v1, v2, 10, v1
    s_waitcnt lgkmcnt(0)
    s_mov_b32 s18, 1.0
    s_cmp_eq_u32 s3, 0
    s_cselect_b32 s16, s6, s12
    s_cselect_b32 s17, s7, s13
    s_cselect_b32 s18, 0xbfb8aa3b, s18
    s_cmp_eq_u32 s3, 2
    s_cselect_b32 s16, s4, s16
    s_cselect_b32 s17, s5, s17
    s_cmp_eq_u32 s3, 3
    s_cselect_b32 s16, s10, s16
    s_cselect_b32 s17, s11, s17
    global_load_ushort v8, v1, s[16:17] offset:0
    global_load_ushort v9, v1, s[16:17] offset:128
    global_load_ushort v10, v1, s[16:17] offset:256
    global_load_ushort v11, v1, s[16:17] offset:384
    global_load_ushort v12, v1, s[16:17] offset:512
    global_load_ushort v13, v1, s[16:17] offset:640
    global_load_ushort v14, v1, s[16:17] offset:768
    global_load_ushort v15, v1, s[16:17] offset:896
    s_lshl_b32 s19, s3, 13
    s_add_u32 s19, s19, 8388608
    v_lshlrev_b32 v2, 4, v0
    v_add_u32 v2, s19, v2
    s_waitcnt vmcnt(0)
    v_lshlrev_b32 v8, 16, v8
    v_mul_f32 v8, s18, v8
    v_lshlrev_b32 v9, 16, v9
    v_mul_f32 v9, s18, v9
    v_lshlrev_b32 v10, 16, v10
    v_mul_f32 v10, s18, v10
    v_lshlrev_b32 v11, 16, v11
    v_mul_f32 v11, s18, v11
    v_lshlrev_b32 v12, 16, v12
    v_mul_f32 v12, s18, v12
    v_lshlrev_b32 v13, 16, v13
    v_mul_f32 v13, s18, v13
    v_lshlrev_b32 v14, 16, v14
    v_mul_f32 v14, s18, v14
    v_lshlrev_b32 v15, 16, v15
    v_mul_f32 v15, s18, v15
    v_cvt_pk_bf16_f32 v16, v8, v9
    v_cvt_pk_bf16_f32 v17, v10, v11
    v_cvt_pk_bf16_f32 v18, v12, v13
    v_cvt_pk_bf16_f32 v19, v14, v15
    global_store_dwordx4 v2, v[16:19], s[14:15]
    s_endpgm
K1_WC:
    v_cmp_gt_u32 vcc, 128, v0
    s_and_b64 exec, exec, vcc
    s_cbranch_execz K1_END
    v_bfe_u32 v2, v0, 6, 1
    v_lshl_add_u32 v1, v2, 4, v1
    v_lshlrev_b32 v1, 1, v1
    s_waitcnt lgkmcnt(0)
    global_load_ushort v8, v1, s[8:9]
    v_lshlrev_b32 v2, 2, v0
    v_add_u32 v2, 8421376, v2
    v_and_b32 v3, 32, v0
    v_cmp_eq_u32 vcc, 0, v3
    v_mov_b32 v4, 0
    s_waitcnt vmcnt(0)
    v_lshlrev_b32 v8, 16, v8
    v_mul_f32 v8, 0xbfb8aa3b, v8
    v_cvt_pk_bf16_f32 v9, v4, v8
    v_sub_f32 v10, v8, v9
    v_cvt_pk_bf16_f32 v10, v4, v10
    v_or_b32 v9, 0x7f7f, v9
    v_cndmask_b32 v9, v10, v9, vcc
    global_store_dword v2, v9, s[14:15]
K1_END:
    s_endpgm
.globl main_kernel
.p2align 8
.type main_kernel,@function
main_kernel:
    s_cmp_ge_u32 s2, 256
    s_cbranch_scc1 K2_END
    s_load_dwordx2 s[8:9], s[0:1], 88
    s_load_dwordx2 s[4:5], s[0:1], 0
    s_load_dwordx2 s[20:21], s[0:1], 72
    v_lshrrev_b32 v1, 6, v0
    s_mov_b32 s10, 8192000
    s_mov_b32 s11, 0x20000
    v_readfirstlane_b32 s3, v1
    s_and_b32 s48, s2, 7
    s_lshr_b32 s2, s2, 3
    s_lshl_b32 s48, s48, 5
    s_or_b32 s2, s2, s48
    v_mbcnt_lo_u32_b32 v20, -1, 0
    v_mbcnt_hi_u32_b32 v20, -1, v20
    s_lshl_b32 s48, s3, 6
    v_add_u32 v21, s48, v20
    v_lshrrev_b32 v22, 3, v21
    v_and_b32 v23, 7, v20
    v_lshlrev_b32 v23, 4, v23
    s_lshl_b32 s49, s2, 7
    v_lshl_add_u32 v176, v22, 15, s49
    v_add_u32 v176, v176, v23
    v_add_u32 v177, 2097152, v176
    v_add_u32 v178, 4194304, v176
    v_add_u32 v179, 6291456, v176
    s_waitcnt lgkmcnt(0)
    buffer_load_dwordx4 v[128:131], v176, s[8:11], 0 offen nt
    buffer_load_dwordx4 v[132:135], v177, s[8:11], 0 offen nt
    s_add_u32 s16, s8, 8388608
    s_addc_u32 s17, s9, 0
    s_mov_b32 s18, 33792
    s_mov_b32 s19, 0x20000
    s_add_u32 s12, s8, 8650752
    s_addc_u32 s13, s9, 0
    s_mov_b32 s14, 8529280
    s_mov_b32 s15, 0x20000
    s_mov_b32 s45, 0
    s_mov_b32 s46, 0
    s_mov_b32 s47, 0
    s_movk_i32 s36, 192
    s_sub_u32 s4, s4, 3120
    s_subb_u32 s5, s5, 0
    s_mov_b32 s6, 6403120
    s_mov_b32 s7, 0x20000
    s_mov_b32 s22, 6400000
    s_mov_b32 s23, 0x20000
    s_add_u32 s24, s8, 17825792
    s_addc_u32 s25, s9, 0
    s_mov_b32 s26, 25600000
    s_mov_b32 s27, 0x20000
K2_RESTART:
    v_lshlrev_b32 v28, 2, v20
    v_lshlrev_b32 v24, 4, v21
    v_mov_b32 v96, 0xffff
    v_mov_b32 v97, 0xffff
    v_mov_b32 v98, 0xffff
    v_mov_b32 v99, 0xffff
    v_add_u32 v25, 60736, v24
    v_mul_u32_u24 v187, 208, v21
    v_add_u32 v187, 60736, v187
    v_cmp_gt_u32 vcc, 256, v21
    v_lshlrev_b32 v30, 2, v21
    ds_write_b128 v25, v[96:99]
    ds_write_b128 v25, v[96:99] offset:8192
    v_cndmask_b32 v187, 0, v187, vcc
    ds_write_b128 v25, v[96:99] offset:16384
    ds_write_b128 v25, v[96:99] offset:24576
    v_cmp_gt_u32 vcc, 336, v21
    ds_write_b128 v25, v[96:99] offset:32768
    s_mul_i32 s48, s3, 3328
    v_add_u32 v26, s48, v28
    ds_write_b32 v26, v96
    s_and_b64 exec, exec, vcc
    ds_write_b32 v30, v187 offset:59392
    s_mov_b64 exec, -1
    buffer_load_dwordx4 v[136:139], v178, s[8:11], 0 offen nt
    buffer_load_dwordx4 v[140:143], v179, s[8:11], 0 offen nt
    v_add_u32 v29, 32768, v28
    buffer_load_dword v12, v29, s[16:19], 0 offen
    buffer_load_dword v14, v29, s[16:19], 0 offen offset:256
    s_mov_b32 s28, 3120
    s_and_b32 s48, s3, 1
    s_lshl_b32 s48, s48, 6
    v_and_b32 v102, 0x30, v20
    v_or_b32 v102, s48, v102
    v_xor_b32 v102, v102, v24
    v_and_b32 v102, 4095, v102
    s_mul_i32 s51, s2, 25088
    v_add_u32 v184, s51, v102
    v_lshlrev_b32 v110, 4, v20
    s_and_b32 s50, s3, 3
    s_lshl_b32 s50, s50, 10
    v_lshrrev_b32 v186, 2, v176
    s_mov_b32 s29, 2080
    s_mov_b32 s30, 1040
    s_mov_b32 s31, 128
    s_mov_b32 s32, 50000
    s_mov_b32 s34, 1.0
    s_mov_b32 s35, 1.0
    s_mov_b32 s39, 0
    s_mul_i32 s40, s3, 12480
    s_add_u32 s40, s40, 60736
    s_add_u32 s41, s40, 12480
    s_lshl_b32 s48, s3, 2
    s_lshr_b32 s44, 0x72106453, s48
    s_and_b32 s44, s44, 7
    s_waitcnt lgkmcnt(0)
    s_barrier
    v_mov_b32 v13, 0
    v_mov_b32 v15, 0
    v_mov_b32 v11, 0
    v_mov_b32 v31, 4
    v_bfe_u32 v3, v20, 4, 1
    v_lshlrev_b32 v3, 6, v3
    v_xor_b32 v3, v3, v23
    v_bfe_u32 v102, v20, 2, 2
    v_bfe_u32 v103, v20, 4, 1
    v_lshl_or_b32 v102, v102, 1, v103
    v_and_b32 v103, 3, v20
    v_lshl_or_b32 v9, v102, 2, v103
    v_lshlrev_b32 v9, 2, v9
    v_lshrrev_b32 v8, 3, v20
    v_lshlrev_b32 v8, 4, v8
    s_cmp_ge_u32 s44, 3
    s_cselect_b32 s49, 0x7c, 0x3c
    s_cmp_eq_u32 s44, 0
    s_cselect_b32 s49, 0x1c, s49
    s_mul_i32 s48, s44, 3328
    v_and_b32 v189, s49, v8
    v_and_b32 v190, s49, v9
    v_add_u32 v189, s48, v189
    v_add_u32 v190, s48, v190
    v_add_u32 v9, s48, v9
    v_add_u32 v8, s48, v8
    v_and_b32 v122, 32, v20
    v_lshlrev_b32 v122, 1, v122
    v_add_u32 v122, 110720, v122
    s_add_u32 s49, s49, 4
    s_ff1_i32_b32 s54, s49
    s_sub_u32 s54, s54, 2
    s_lshr_b32 s37, 1024, s54
    v_lshrrev_b32 v188, s54, v20
    v_bfe_u32 v191, v20, 0, s54
    v_lshl_add_u32 v191, v191, 2, s48
    s_lshl_b32 s55, s49, 2
    v_mad_u32_u24 v176, v188, s55, v191
    v_add_u32 v177, s49, v176
    v_add_u32 v178, s49, v177
    v_add_u32 v179, s49, v178
    v_lshlrev_b32 v188, 4, v188
    v_mul_u32_u24 v1, 1040, v103
    v_lshl_add_u32 v1, v102, 7, v1
    v_bfe_u32 v103, v102, 1, 1
    v_lshrrev_b32 v102, 5, v20
    v_xor_b32 v103, v103, v102
    v_lshl_add_u32 v1, v103, 6, v1
    s_mul_i32 s48, s2, 196
    s_sub_u32 s49, 50000, s48
    s_min_u32 s49, s49, 196
    v_cmp_gt_u32 s[52:53], s49, v21
    v_add_u32 v109, s48, v21
    s_or_b32 s38, s45, s47
    s_cbranch_scc1 K2_SLOWLOAD
    s_mov_b64 s[88:89], 0
    s_mov_b64 s[90:91], 0
    s_mov_b64 s[92:93], 0
    s_mov_b64 s[94:95], 0
    s_waitcnt vmcnt(5)
    v_lshlrev_b32_sdwa v144, 2, v131 dst_sel:DWORD dst_unused:UNUSED_PAD src0_sel:DWORD src1_sel:BYTE_0
    v_lshlrev_b32_sdwa v145, 2, v131 dst_sel:DWORD dst_unused:UNUSED_PAD src0_sel:DWORD src1_sel:BYTE_1
    v_lshlrev_b32_sdwa v146, 2, v131 dst_sel:DWORD dst_unused:UNUSED_PAD src0_sel:DWORD src1_sel:BYTE_2
    v_cmpx_ne_u32 s[64:65], 0, v144
    ds_add_rtn_u32 v160, v144, v31 offset:59388
    v_cmpx_ne_u32 s[66:67], 0, v145
    ds_add_rtn_u32 v161, v145, v31 offset:59388
    v_cmpx_ne_u32 s[68:69], 0, v146
    ds_add_rtn_u32 v162, v146, v31 offset:59388
    s_mov_b64 exec, -1
    s_waitcnt vmcnt(4)
    v_lshlrev_b32_sdwa v147, 2, v135 dst_sel:DWORD dst_unused:UNUSED_PAD src0_sel:DWORD src1_sel:BYTE_0
    v_lshlrev_b32_sdwa v148, 2, v135 dst_sel:DWORD dst_unused:UNUSED_PAD src0_sel:DWORD src1_sel:BYTE_1
    v_lshlrev_b32_sdwa v149, 2, v135 dst_sel:DWORD dst_unused:UNUSED_PAD src0_sel:DWORD src1_sel:BYTE_2
    v_cmpx_ne_u32 s[70:71], 0, v147
    ds_add_rtn_u32 v163, v147, v31 offset:59388
    v_cmpx_ne_u32 s[72:73], 0, v148
    ds_add_rtn_u32 v164, v148, v31 offset:59388
    v_cmpx_ne_u32 s[74:75], 0, v149
    ds_add_rtn_u32 v165, v149, v31 offset:59388
    s_mov_b64 exec, -1
    s_waitcnt lgkmcnt(0)
    s_mov_b64 exec, s[64:65]
    ds_write_b32 v160, v128
    s_mov_b64 exec, s[66:67]
    ds_write_b32 v161, v129
    s_mov_b64 exec, s[68:69]
    ds_write_b32 v162, v130
    s_mov_b64 exec, s[70:71]
    ds_write_b32 v163, v132
    s_mov_b64 exec, s[72:73]
    ds_write_b32 v164, v133
    s_mov_b64 exec, s[74:75]
    ds_write_b32 v165, v134
    s_mov_b64 exec, -1
    s_lshl_b32 s48, s3, 10
    s_add_u32 m0, s48, 43008
    s_movk_i32 s49, 16384
    buffer_load_dwordx4 v24, s[16:19], s49 offen lds
    s_add_u32 m0, s48, 26624
    s_movk_i32 s49, 0
    buffer_load_dwordx4 v24, s[16:19], s49 offen lds
    s_add_u32 m0, s48, 34816
    s_movk_i32 s49, 8192
    buffer_load_dwordx4 v24, s[16:19], s49 offen lds
    s_add_u32 m0, s48, 51200
    s_movk_i32 s49, 24576
    buffer_load_dwordx4 v24, s[16:19], s49 offen lds
    s_waitcnt vmcnt(7)
    v_lshlrev_b32_sdwa v150, 2, v139 dst_sel:DWORD dst_unused:UNUSED_PAD src0_sel:DWORD src1_sel:BYTE_0
    v_lshlrev_b32_sdwa v151, 2, v139 dst_sel:DWORD dst_unused:UNUSED_PAD src0_sel:DWORD src1_sel:BYTE_1
    v_lshlrev_b32_sdwa v152, 2, v139 dst_sel:DWORD dst_unused:UNUSED_PAD src0_sel:DWORD src1_sel:BYTE_2
    v_cmpx_ne_u32 s[76:77], 0, v150
    ds_add_rtn_u32 v166, v150, v31 offset:59388
    v_cmpx_ne_u32 s[78:79], 0, v151
    ds_add_rtn_u32 v167, v151, v31 offset:59388
    v_cmpx_ne_u32 s[80:81], 0, v152
    ds_add_rtn_u32 v168, v152, v31 offset:59388
    s_mov_b64 exec, -1
    s_waitcnt vmcnt(6)
    v_lshlrev_b32_sdwa v153, 2, v143 dst_sel:DWORD dst_unused:UNUSED_PAD src0_sel:DWORD src1_sel:BYTE_0
    v_lshlrev_b32_sdwa v154, 2, v143 dst_sel:DWORD dst_unused:UNUSED_PAD src0_sel:DWORD src1_sel:BYTE_1
    v_lshlrev_b32_sdwa v155, 2, v143 dst_sel:DWORD dst_unused:UNUSED_PAD src0_sel:DWORD src1_sel:BYTE_2
    v_cmpx_ne_u32 s[82:83], 0, v153
    ds_add_rtn_u32 v169, v153, v31 offset:59388
    v_cmpx_ne_u32 s[84:85], 0, v154
    ds_add_rtn_u32 v170, v154, v31 offset:59388
    v_cmpx_ne_u32 s[86:87], 0, v155
    ds_add_rtn_u32 v171, v155, v31 offset:59388
    s_mov_b64 exec, -1
    v_or3_b32 v102, v131, v135, v139
    v_or_b32 v102, v102, v143
    v_cmp_lt_u32 vcc, 0xffffff, v102
    s_waitcnt lgkmcnt(0)
    s_mov_b64 exec, s[76:77]
    ds_write_b32 v166, v136
    s_mov_b64 exec, s[78:79]
    ds_write_b32 v167, v137
    s_mov_b64 exec, s[80:81]
    ds_write_b32 v168, v138
    s_mov_b64 exec, s[82:83]
    ds_write_b32 v169, v140
    s_mov_b64 exec, s[84:85]
    ds_write_b32 v170, v141
    s_mov_b64 exec, s[86:87]
    ds_write_b32 v171, v142
    s_mov_b64 exec, -1
K2_CNT1:
    s_cbranch_vccnz K2_X3
K2_COUNTED:
    s_cmp_ge_u32 s3, 4
    s_cbranch_scc1 K2_YOUNG
    s_waitcnt lgkmcnt(0)
    s_barrier
    ds_read_b32 v111, v30 offset:59392
    v_mov_b32 v107, 60708
    v_mov_b32 v108, 1
    s_waitcnt lgkmcnt(0)
    v_sub_u32 v111, v111, v187
    v_cmp_lt_u32 vcc, s36, v111
    v_min_u32 v111, s36, v111
    v_sub_u32 v112, 252, v111
    s_mov_b64 exec, s[52:53]
    ds_add_rtn_u32 v113, v112, v108 offset:60416
    s_and_b64 exec, exec, vcc
    ds_write_b32 v107, v107
    s_mov_b64 exec, -1
    s_waitcnt lgkmcnt(0)
    s_barrier
    ds_read_b32 v114, v28 offset:60416
    s_waitcnt lgkmcnt(0)
    v_mov_b32 v115, v114
    s_nop 1
    v_add_u32_dpp v114, v114, v114 row_shr:1 row_mask:0xf bank_mask:0xf
    s_nop 1
    v_add_u32_dpp v114, v114, v114 row_shr:2 row_mask:0xf bank_mask:0xf
    s_nop 1
    v_add_u32_dpp v114, v114, v114 row_shr:4 row_mask:0xf bank_mask:0xf
    s_nop 1
    v_add_u32_dpp v114, v114, v114 row_shr:8 row_mask:0xf bank_mask:0xf
    s_nop 1
    v_add_u32_dpp v114, v114, v114 row_bcast:15 row_mask:0xa bank_mask:0xf
    s_nop 1
    v_add_u32_dpp v114, v114, v114 row_bcast:31 row_mask:0xc bank_mask:0xf
    v_sub_u32 v114, v114, v115
    ds_bpermute_b32 v114, v112, v114
    v_mov_b32 v118, 128
    s_movk_i32 s48, 3328
    s_waitcnt lgkmcnt(0)
    v_add_u32 v114, v114, v113
    v_add_u32 v115, 56, v114
    v_lshrrev_b32 v116, 5, v115
    v_and_b32 v117, 31, v115
    v_add_u32 v115, 8, v114
    v_cmp_gt_u32 vcc, 40, v114
    v_cmp_gt_u32 s[54:55], 8, v114
    v_lshrrev_b32 v119, 4, v115
    v_and_b32 v120, 15, v115
    v_cndmask_b32 v116, v116, v119, vcc
    v_cndmask_b32 v117, v117, v120, vcc
    v_cndmask_b32 v118, v118, 64, vcc
    v_cndmask_b32 v117, v117, v114, s[54:55]
    v_cndmask_b32 v118, v118, 32, s[54:55]
    v_lshlrev_b32 v117, 2, v117
    v_mad_u32_u24 v117, v116, s48, v117
    v_mul_u32_u24 v118, v111, v118
    v_add_u32 v118, 511, v118
    v_lshrrev_b32 v118, 9, v118
    v_lshlrev_b32 v116, 2, v116
    s_mov_b64 exec, s[52:53]
    ds_write_b32 v117, v109
    ds_max_u32 v116, v118 offset:60672
    s_mov_b64 exec, -1
    s_waitcnt vmcnt(0)
    s_branch K2_B4
K2_YOUNG:
    s_waitcnt lgkmcnt(0)
    s_barrier
    v_cmp_gt_u32 vcc, 288, v21
    s_add_u32 m0, s50, 110720
    s_add_u32 s49, s28, 0
    buffer_load_dwordx4 v184, s[4:7], s49 offen nt lds
    s_add_u32 m0, s50, 114816
    s_add_u32 s49, s28, 4096
    buffer_load_dwordx4 v184, s[4:7], s49 offen nt lds
    s_add_u32 m0, s50, 118912
    s_add_u32 s49, s28, 8192
    buffer_load_dwordx4 v184, s[4:7], s49 offen nt lds
    s_add_u32 m0, s50, 123008
    s_add_u32 s49, s28, 12288
    buffer_load_dwordx4 v184, s[4:7], s49 offen nt lds
    s_add_u32 m0, s50, 127104
    s_add_u32 s49, s28, 16384
    buffer_load_dwordx4 v184, s[4:7], s49 offen nt lds
    s_add_u32 m0, s50, 131200
    s_add_u32 s49, s28, 20480
    buffer_load_dwordx4 v184, s[4:7], s49 offen nt lds
    s_add_u32 m0, s50, 135296
    s_add_u32 s49, s28, 24576
    s_or_b64 exec, vcc, 1
    buffer_load_dwordx4 v184, s[4:7], s49 offen nt lds
    s_mov_b64 exec, -1
    s_barrier
    s_waitcnt vmcnt(7)
    v_lshlrev_b32 v107, 12, v20
    v_min_u32 v107, 25084, v107
    s_mov_b32 m0, 59392
    s_mov_b64 exec, 0xff
    buffer_load_dword v107, s[20:23], s51 offen lds
    s_mov_b64 exec, -1
K2_B4:
    s_cmp_lg_u32 s39, 0
    s_cbranch_scc1 K2_X3PUT
K2_B4B:
    s_mul_i32 s48, s2, 196
    s_movk_i32 s49, 208
    s_waitcnt lgkmcnt(0)
    s_barrier
    ds_read_b32 v120, v191
    ds_read_b32 v123, v28 offset:60672
    ds_read_b32 v121, v190
    ds_read_b128 v[4:7], v189
    s_waitcnt lgkmcnt(2)
    v_subrev_u32 v120, s48, v120
    v_min_u32 v120, 196, v120
    v_mad_u32_u24 v120, v120, s49, v188
    v_add_u32 v119, s37, v120
    v_add_u32 v118, s37, v119
    v_cmp_lt_u32 vcc, 24, v123
    ds_read_b128 v[208:211], v120 offset:60736
    ds_read_b128 v[212:215], v119 offset:60736
    ds_read_b128 v[216:219], v118 offset:60736
    v_readlane_b32 s43, v123, s44
    s_waitcnt lgkmcnt(4)
    v_subrev_u32 v121, s48, v121
    v_min_u32 v121, 195, v121
    v_lshlrev_b32 v124, 3, v121
    v_and_b32 v124, 0x70, v124
    v_xor_b32 v124, v124, v122
    v_lshl_add_u32 v124, v121, 7, v124
    v_xor_b32 v125, 16, v124
    v_xor_b32 v126, 32, v124
    v_xor_b32 v127, 48, v124
    s_mov_b32 s47, 0
    s_and_b32 s33, vcc_lo, 0x3ff
    s_cbranch_scc1 K2_FLAGS
K2_FLAGSDONE:
    s_lshl_b32 s48, s43, 7
    v_add_u32 v121, s48, v8
    v_mov_b32 v0, v110
    s_mov_b32 m0, s40
    s_cmp_ge_u32 s3, 4
    s_cbranch_scc1 K2_YPRE
    s_waitcnt lgkmcnt(0)
    ds_write_b32 v176, v208 offset:128
    ds_write_b32 v177, v209 offset:128
    ds_write_b32 v178, v210 offset:128
    ds_write_b32 v179, v211 offset:128
    ds_write_b32 v176, v212 offset:1152
    ds_write_b32 v177, v213 offset:1152
    ds_write_b32 v178, v214 offset:1152
    ds_write_b32 v179, v215 offset:1152
    ds_write_b32 v176, v216 offset:2176
    ds_write_b32 v177, v217 offset:2176
    ds_write_b32 v178, v218 offset:2176
    ds_write_b32 v179, v219 offset:2176
    ds_write_b128 v121, v[4:7] offset:128
    ds_read_b128 v[4:7], v8 offset:128
    ds_read_b128 v[192:195], v8 offset:256
    ds_read_b128 v[196:199], v8 offset:384
    ds_read_b128 v[200:203], v8 offset:512
    ds_read_b32 v10, v9 offset:128
    s_waitcnt lgkmcnt(4)
    s_barrier
    v_mad_u32_u16 v4, v4, s31, v3
    v_mad_u32_u16 v5, v5, s31, v3
    v_mad_u32_u16 v6, v6, s31, v3
    v_mad_u32_u16 v7, v7, s31, v3
    buffer_load_dwordx4 v4, s[4:7], s28 offen  lds
    buffer_load_dwordx4 v5, s[4:7], s29 offen offset:1040  lds
    buffer_load_dwordx4 v6, s[4:7], s30 offen offset:2080  lds
    buffer_load_dwordx4 v7, s[4:7], 0 offen offset:3120  lds
    ds_read_b128 v[224:227], v0 offset:43008
    ds_read_b128 v[228:231], v0 offset:44032
    ds_read_b128 v[232:235], v0 offset:45056
    ds_read_b128 v[236:239], v0 offset:46080
    ds_read_b128 v[240:243], v0 offset:47104
    ds_read_b128 v[244:247], v0 offset:48128
    ds_read_b128 v[248:251], v0 offset:49152
    ds_read_b128 v[252:255], v0 offset:50176
    s_waitcnt lgkmcnt(8)
    s_add_u32 m0, s40, 4160
    v_mad_u32_u16 v4, v192, s31, v3
    v_mad_u32_u16 v5, v193, s31, v3
    v_mad_u32_u16 v6, v194, s31, v3
    v_mad_u32_u16 v7, v195, s31, v3
    buffer_load_dwordx4 v4, s[4:7], s28 offen  lds
    buffer_load_dwordx4 v5, s[4:7], s29 offen offset:1040  lds
    buffer_load_dwordx4 v6, s[4:7], s30 offen offset:2080  lds
    buffer_load_dwordx4 v7, s[4:7], 0 offen offset:3120  lds
    ds_read_b128 v[32:35], v0 offset:26624
    ds_read_b128 v[36:39], v0 offset:27648
    ds_read_b128 v[40:43], v0 offset:28672
    ds_read_b128 v[44:47], v0 offset:29696
    ds_read_b128 v[48:51], v0 offset:30720
    ds_read_b128 v[52:55], v0 offset:31744
    ds_read_b128 v[56:59], v0 offset:32768
    ds_read_b128 v[60:63], v0 offset:33792
    s_add_u32 m0, s40, 8320
    v_mad_u32_u16 v4, v196, s31, v3
    v_mad_u32_u16 v5, v197, s31, v3
    v_mad_u32_u16 v6, v198, s31, v3
    v_mad_u32_u16 v7, v199, s31, v3
    buffer_load_dwordx4 v4, s[4:7], s28 offen  lds
    buffer_load_dwordx4 v5, s[4:7], s29 offen offset:1040  lds
    buffer_load_dwordx4 v6, s[4:7], s30 offen offset:2080  lds
    buffer_load_dwordx4 v7, s[4:7], 0 offen offset:3120  lds
    ds_read_b128 v[64:67], v0 offset:34816
    ds_read_b128 v[68:71], v0 offset:35840
    ds_read_b128 v[72:75], v0 offset:36864
    ds_read_b128 v[76:79], v0 offset:37888
    ds_read_b128 v[80:83], v0 offset:38912
    ds_read_b128 v[84:87], v0 offset:39936
    ds_read_b128 v[88:91], v0 offset:40960
    ds_read_b128 v[92:95], v0 offset:41984
    s_mov_b32 s54, 0x350637bd
    s_cmp_ge_u32 s44, 3
    s_cselect_b32 s54, 0x358637bd, s54
    s_cmp_eq_u32 s44, 0
    s_cselect_b32 s54, 0x348637bd, s54
    v_mov_b32 v128, s54
    v_mov_b32 v129, s54
    v_mov_b32 v130, s54
    v_mov_b32 v131, s54
    v_mov_b32 v132, s54
    v_mov_b32 v133, s54
    v_mov_b32 v134, s54
    v_mov_b32 v135, s54
    v_mov_b32 v136, s54
    v_mov_b32 v137, s54
    v_mov_b32 v138, s54
    v_mov_b32 v139, s54
    v_mov_b32 v140, s54
    v_mov_b32 v141, s54
    v_mov_b32 v142, s54
    v_mov_b32 v143, s54
    v_mov_b32 v144, s54
    v_mov_b32 v145, s54
    v_mov_b32 v146, s54
    v_mov_b32 v147, s54
    v_mov_b32 v148, s54
    v_mov_b32 v149, s54
    v_mov_b32 v150, s54
    v_mov_b32 v151, s54
    v_mov_b32 v152, s54
    v_mov_b32 v153, s54
    v_mov_b32 v154, s54
    v_mov_b32 v155, s54
    v_mov_b32 v156, s54
    v_mov_b32 v157, s54
    v_mov_b32 v158, s54
    v_mov_b32 v159, s54
    v_mov_b32 v160, 0
    v_mov_b32 v161, 0
    v_mov_b32 v162, 0
    v_mov_b32 v163, 0
    v_mov_b32 v164, 0
    v_mov_b32 v165, 0
    v_mov_b32 v166, 0
    v_mov_b32 v167, 0
    v_mov_b32 v168, 0
    v_mov_b32 v169, 0
    v_mov_b32 v170, 0
    v_mov_b32 v171, 0
    v_mov_b32 v172, 0
    v_mov_b32 v173, 0
    v_mov_b32 v174, 0
    v_mov_b32 v175, 0
    v_mov_b32 v176, 0
    v_mov_b32 v177, 0
    v_mov_b32 v178, 0
    v_mov_b32 v179, 0
    v_mov_b32 v180, 0
    v_mov_b32 v181, 0
    v_mov_b32 v182, 0
    v_mov_b32 v183, 0
    v_mov_b32 v184, 0
    v_mov_b32 v185, 0
    v_mov_b32 v186, 0
    v_mov_b32 v187, 0
    v_mov_b32 v188, 0
    v_mov_b32 v189, 0
    v_mov_b32 v190, 0
    v_mov_b32 v191, 0
    s_barrier
    ds_read_b128 v[16:19], v124
    ds_read_b128 v[20:23], v125
    ds_read_b128 v[24:27], v126
    ds_read_b128 v[28:31], v127
    s_waitcnt lgkmcnt(0)
    v_mfma_f32_32x32x16_bf16 v[96:111], v[224:227], v[16:19], 0
    v_mfma_f32_32x32x16_bf16 v[112:127], v[240:243], v[16:19], 0
    v_mfma_f32_32x32x16_bf16 v[96:111], v[228:231], v[20:23], v[96:111]
    v_mfma_f32_32x32x16_bf16 v[112:127], v[244:247], v[20:23], v[112:127]
    v_mfma_f32_32x32x16_bf16 v[96:111], v[232:235], v[24:27], v[96:111]
    v_mfma_f32_32x32x16_bf16 v[112:127], v[248:251], v[24:27], v[112:127]
    v_mfma_f32_32x32x16_bf16 v[96:111], v[236:239], v[28:31], v[96:111]
    v_mfma_f32_32x32x16_bf16 v[112:127], v[252:255], v[28:31], v[112:127]
    s_barrier
    s_branch K2_PRE
K2_YPRE:
    s_waitcnt lgkmcnt(0)
    s_barrier
    ds_write_b32 v176, v208 offset:128
    ds_write_b32 v177, v209 offset:128
    ds_write_b32 v178, v210 offset:128
    ds_write_b32 v179, v211 offset:128
    ds_write_b32 v176, v212 offset:1152
    ds_write_b32 v177, v213 offset:1152
    ds_write_b32 v178, v214 offset:1152
    ds_write_b32 v179, v215 offset:1152
    ds_write_b32 v176, v216 offset:2176
    ds_write_b32 v177, v217 offset:2176
    ds_write_b32 v178, v218 offset:2176
    ds_write_b32 v179, v219 offset:2176
    ds_write_b128 v121, v[4:7] offset:128
    ds_read_b128 v[4:7], v8 offset:128
    ds_read_b128 v[192:195], v8 offset:256
    ds_read_b128 v[196:199], v8 offset:384
    ds_read_b128 v[200:203], v8 offset:512
    ds_read_b32 v10, v9 offset:128
    s_mov_b32 s54, 0x350637bd
    s_cmp_ge_u32 s44, 3
    s_cselect_b32 s54, 0x358637bd, s54
    s_cmp_eq_u32 s44, 0
    s_cselect_b32 s54, 0x348637bd, s54
    v_mov_b32 v128, s54
    v_mov_b32 v129, s54
    v_mov_b32 v130, s54
    v_mov_b32 v131, s54
    v_mov_b32 v132, s54
    v_mov_b32 v133, s54
    v_mov_b32 v134, s54
    v_mov_b32 v135, s54
    v_mov_b32 v136, s54
    v_mov_b32 v137, s54
    v_mov_b32 v138, s54
    v_mov_b32 v139, s54
    v_mov_b32 v140, s54
    v_mov_b32 v141, s54
    v_mov_b32 v142, s54
    v_mov_b32 v143, s54
    v_mov_b32 v144, s54
    v_mov_b32 v145, s54
    v_mov_b32 v146, s54
    v_mov_b32 v147, s54
    v_mov_b32 v148, s54
    v_mov_b32 v149, s54
    v_mov_b32 v150, s54
    v_mov_b32 v151, s54
    v_mov_b32 v152, s54
    v_mov_b32 v153, s54
    v_mov_b32 v154, s54
    v_mov_b32 v155, s54
    v_mov_b32 v156, s54
    v_mov_b32 v157, s54
    v_mov_b32 v158, s54
    v_mov_b32 v159, s54
    v_mov_b32 v160, 0
    v_mov_b32 v161, 0
    v_mov_b32 v162, 0
    v_mov_b32 v163, 0
    v_mov_b32 v164, 0
    v_mov_b32 v165, 0
    v_mov_b32 v166, 0
    v_mov_b32 v167, 0
    v_mov_b32 v168, 0
    v_mov_b32 v169, 0
    v_mov_b32 v170, 0
    v_mov_b32 v171, 0
    v_mov_b32 v172, 0
    v_mov_b32 v173, 0
    v_mov_b32 v174, 0
    v_mov_b32 v175, 0
    v_mov_b32 v176, 0
    v_mov_b32 v177, 0
    v_mov_b32 v178, 0
    v_mov_b32 v179, 0
    v_mov_b32 v180, 0
    v_mov_b32 v181, 0
    v_mov_b32 v182, 0
    v_mov_b32 v183, 0
    v_mov_b32 v184, 0
    v_mov_b32 v185, 0
    v_mov_b32 v186, 0
    v_mov_b32 v187, 0
    v_mov_b32 v188, 0
    v_mov_b32 v189, 0
    v_mov_b32 v190, 0
    v_mov_b32 v191, 0
    s_waitcnt vmcnt(1)
    s_barrier
    ds_read_b128 v[16:19], v124
    ds_read_b128 v[20:23], v125
    ds_read_b128 v[24:27], v126
    ds_read_b128 v[28:31], v127
    s_waitcnt lgkmcnt(0)
    s_barrier
    ds_read_b128 v[224:227], v0 offset:43008
    ds_read_b128 v[228:231], v0 offset:44032
    ds_read_b128 v[232:235], v0 offset:45056
    ds_read_b128 v[236:239], v0 offset:46080
    ds_read_b128 v[240:243], v0 offset:47104
    ds_read_b128 v[244:247], v0 offset:48128
    ds_read_b128 v[248:251], v0 offset:49152
    ds_read_b128 v[252:255], v0 offset:50176
    ds_read_b128 v[32:35], v0 offset:26624
    ds_read_b128 v[36:39], v0 offset:27648
    ds_read_b128 v[40:43], v0 offset:28672
    ds_read_b128 v[44:47], v0 offset:29696
    ds_read_b128 v[48:51], v0 offset:30720
    ds_read_b128 v[52:55], v0 offset:31744
    ds_read_b128 v[56:59], v0 offset:32768
    ds_read_b128 v[60:63], v0 offset:33792
    s_waitcnt lgkmcnt(8)
    v_mfma_f32_32x32x16_bf16 v[96:111], v[224:227], v[16:19], 0
    v_mfma_f32_32x32x16_bf16 v[112:127], v[240:243], v[16:19], 0
    v_mfma_f32_32x32x16_bf16 v[96:111], v[228:231], v[20:23], v[96:111]
    v_mfma_f32_32x32x16_bf16 v[112:127], v[244:247], v[20:23], v[112:127]
    v_mfma_f32_32x32x16_bf16 v[96:111], v[232:235], v[24:27], v[96:111]
    v_mfma_f32_32x32x16_bf16 v[112:127], v[248:251], v[24:27], v[112:127]
    v_mfma_f32_32x32x16_bf16 v[96:111], v[236:239], v[28:31], v[96:111]
    v_mfma_f32_32x32x16_bf16 v[112:127], v[252:255], v[28:31], v[112:127]
    ds_read_b128 v[64:67], v0 offset:34816
    ds_read_b128 v[68:71], v0 offset:35840
    ds_read_b128 v[72:75], v0 offset:36864
    ds_read_b128 v[76:79], v0 offset:37888
    ds_read_b128 v[80:83], v0 offset:38912
    ds_read_b128 v[84:87], v0 offset:39936
    ds_read_b128 v[88:91], v0 offset:40960
    ds_read_b128 v[92:95], v0 offset:41984
    v_mad_u32_u16 v4, v4, s31, v3
    v_mad_u32_u16 v5, v5, s31, v3
    v_mad_u32_u16 v6, v6, s31, v3
    v_mad_u32_u16 v7, v7, s31, v3
    buffer_load_dwordx4 v4, s[4:7], s28 offen  lds
    buffer_load_dwordx4 v5, s[4:7], s29 offen offset:1040  lds
    buffer_load_dwordx4 v6, s[4:7], s30 offen offset:2080  lds
    buffer_load_dwordx4 v7, s[4:7], 0 offen offset:3120  lds
    s_add_u32 m0, s40, 4160
    v_mad_u32_u16 v4, v192, s31, v3
    v_mad_u32_u16 v5, v193, s31, v3
    v_mad_u32_u16 v6, v194, s31, v3
    v_mad_u32_u16 v7, v195, s31, v3
    buffer_load_dwordx4 v4, s[4:7], s28 offen  lds
    buffer_load_dwordx4 v5, s[4:7], s29 offen offset:1040  lds
    buffer_load_dwordx4 v6, s[4:7], s30 offen offset:2080  lds
    buffer_load_dwordx4 v7, s[4:7], 0 offen offset:3120  lds
    s_add_u32 m0, s40, 8320
    v_mad_u32_u16 v4, v196, s31, v3
    v_mad_u32_u16 v5, v197, s31, v3
    v_mad_u32_u16 v6, v198, s31, v3
    v_mad_u32_u16 v7, v199, s31, v3
    buffer_load_dwordx4 v4, s[4:7], s28 offen  lds
    buffer_load_dwordx4 v5, s[4:7], s29 offen offset:1040  lds
    buffer_load_dwordx4 v6, s[4:7], s30 offen offset:2080  lds
    buffer_load_dwordx4 v7, s[4:7], 0 offen offset:3120  lds
K2_PRE:
    v_mad_u32_u16 v4, v200, s31, v3
    v_mad_u32_u16 v5, v201, s31, v3
    v_mad_u32_u16 v6, v202, s31, v3
    v_mad_u32_u16 v7, v203, s31, v3
    v_pk_sub_u16 v10, v10, s32 clamp
    v_add_u32 v2, s40, v1
    v_add_u32 v8, 640, v8
    v_add_u32 v9, 256, v9
    s_cmp_lg_u32 s46, 0
    s_cbranch_scc1 K2_LOADACC
K2_ACCDONE:
    s_mov_b32 m0, s40
    s_add_u32 s42, s40, 4160
    s_mov_b32 s54, 0xbfb8aa3b
    s_mov_b32 s55, 0xbfb8aa3b
    v_pk_mul_f32 v[96:97], v[96:97], s[54:55]
    v_pk_mul_f32 v[98:99], v[98:99], s[54:55]
    v_pk_mul_f32 v[100:101], v[100:101], s[54:55]
    v_pk_mul_f32 v[102:103], v[102:103], s[54:55]
    v_pk_mul_f32 v[104:105], v[104:105], s[54:55]
    v_pk_mul_f32 v[106:107], v[106:107], s[54:55]
    v_pk_mul_f32 v[108:109], v[108:109], s[54:55]
    v_pk_mul_f32 v[110:111], v[110:111], s[54:55]
    v_pk_mul_f32 v[112:113], v[112:113], s[54:55]
    v_pk_mul_f32 v[114:115], v[114:115], s[54:55]
    v_pk_mul_f32 v[116:117], v[116:117], s[54:55]
    v_pk_mul_f32 v[118:119], v[118:119], s[54:55]
    v_pk_mul_f32 v[120:121], v[120:121], s[54:55]
    v_pk_mul_f32 v[122:123], v[122:123], s[54:55]
    v_pk_mul_f32 v[124:125], v[124:125], s[54:55]
    v_pk_mul_f32 v[126:127], v[126:127], s[54:55]
    s_waitcnt vmcnt(8)
    ds_read_b128 v[16:19], v2
    ds_read_b128 v[20:23], v2 offset:16
    ds_read_b128 v[24:27], v2 offset:32
    ds_read_b128 v[28:31], v2 offset:48
    v_mfma_f32_32x32x8_bf16 v[192:207], v[12:13], v[10:11], v[96:111]
    s_waitcnt lgkmcnt(0)
    v_mfma_f32_32x32x16_bf16 v[192:207], v[32:35], v[16:19], v[192:207]
    buffer_load_dwordx4 v4, s[4:7], s28 offen  lds
    v_mfma_f32_32x32x16_bf16 v[192:207], v[36:39], v[20:23], v[192:207]
    buffer_load_dwordx4 v5, s[4:7], s29 offen offset:1040  lds
    v_mfma_f32_32x32x16_bf16 v[192:207], v[40:43], v[24:27], v[192:207]
    buffer_load_dwordx4 v6, s[4:7], s30 offen offset:2080  lds
    v_mfma_f32_32x32x16_bf16 v[192:207], v[44:47], v[28:31], v[192:207]
    buffer_load_dwordx4 v7, s[4:7], 0 offen offset:3120  lds
    v_mfma_f32_32x32x16_bf16 v[208:223], v[64:67], v[16:19], 0
    v_mfma_f32_32x32x16_bf16 v[208:223], v[68:71], v[20:23], v[208:223]
    v_mfma_f32_32x32x16_bf16 v[208:223], v[72:75], v[24:27], v[208:223]
    v_mfma_f32_32x32x16_bf16 v[208:223], v[76:79], v[28:31], v[208:223]
    v_add_u32 v2, 4160, v2
    s_sub_u32 s43, s43, 1
    s_cbranch_scc1 K2_LOOPEND
    .p2align 4
K2_LOOP:
    v_mfma_f32_32x32x8_bf16 v[224:239], v[14:15], v[10:11], v[112:127]
    ds_read_b32 v0, v9
    v_exp_f32 v192, v192
    v_exp_f32 v193, v193
    v_exp_f32 v194, v194
    v_mfma_f32_32x32x16_bf16 v[224:239], v[48:51], v[16:19], v[224:239]
    s_waitcnt vmcnt(8)
    v_exp_f32 v195, v195
    v_exp_f32 v196, v196
    v_exp_f32 v197, v197
    v_mfma_f32_32x32x16_bf16 v[240:255], v[80:83], v[16:19], 0
    ds_read_b128 v[16:19], v2
    v_exp_f32 v198, v198
    v_exp_f32 v199, v199
    v_exp_f32 v200, v200
    v_mfma_f32_32x32x16_bf16 v[224:239], v[52:55], v[20:23], v[224:239]
    ds_read_b128 v[4:7], v8
    v_exp_f32 v201, v201
    v_exp_f32 v202, v202
    v_exp_f32 v203, v203
    v_mfma_f32_32x32x16_bf16 v[240:255], v[84:87], v[20:23], v[240:255]
    ds_read_b128 v[20:23], v2 offset:16
    v_exp_f32 v204, v204
    v_exp_f32 v205, v205
    v_exp_f32 v206, v206
    v_exp_f32 v207, v207
    v_add_u32 v9, 128, v9
    v_add_u32 v8, 128, v8
    v_pk_add_f32 v[192:193], v[192:193], s[34:35]
    v_pk_add_f32 v[194:195], v[194:195], s[34:35]
    v_pk_add_f32 v[196:197], v[196:197], s[34:35]
    v_pk_add_f32 v[198:199], v[198:199], s[34:35]
    v_pk_add_f32 v[200:201], v[200:201], s[34:35]
    v_pk_add_f32 v[202:203], v[202:203], s[34:35]
    v_pk_add_f32 v[204:205], v[204:205], s[34:35]
    v_pk_add_f32 v[206:207], v[206:207], s[34:35]
    v_mfma_f32_32x32x16_bf16 v[224:239], v[56:59], v[24:27], v[224:239]
    s_mov_b32 m0, s42
    v_rcp_f32 v192, v192
    v_rcp_f32 v193, v193
    v_rcp_f32 v194, v194
    v_mfma_f32_32x32x16_bf16 v[240:255], v[88:91], v[24:27], v[240:255]
    ds_read_b128 v[24:27], v2 offset:32
    v_rcp_f32 v195, v195
    v_rcp_f32 v196, v196
    v_rcp_f32 v197, v197
    v_mfma_f32_32x32x16_bf16 v[224:239], v[60:63], v[28:31], v[224:239]
    s_waitcnt lgkmcnt(2)
    v_rcp_f32 v198, v198
    v_rcp_f32 v199, v199
    v_rcp_f32 v200, v200
    v_mfma_f32_32x32x16_bf16 v[240:255], v[92:95], v[28:31], v[240:255]
    ds_read_b128 v[28:31], v2 offset:48
    v_rcp_f32 v201, v201
    v_rcp_f32 v202, v202
    v_rcp_f32 v203, v203
    v_rcp_f32 v204, v204
    v_rcp_f32 v205, v205
    v_rcp_f32 v206, v206
    v_rcp_f32 v207, v207
    v_pk_sub_u16 v10, v0, s32 clamp
    v_mad_u32_u16 v4, v4, s31, v3
    v_mad_u32_u16 v5, v5, s31, v3
    v_mad_u32_u16 v6, v6, s31, v3
    v_mad_u32_u16 v7, v7, s31, v3
    v_pk_add_f32 v[128:129], v[128:129], v[192:193]
    s_add_u32 s42, s42, 4160
    v_pk_fma_f32 v[160:161], v[192:193], v[208:209], v[160:161]
    s_cmp_eq_u32 s42, s41
    v_pk_add_f32 v[130:131], v[130:131], v[194:195]
    s_cselect_b32 s42, s40, s42
    v_pk_fma_f32 v[162:163], v[194:195], v[210:211], v[162:163]
    s_waitcnt lgkmcnt(0)
    v_pk_add_f32 v[132:133], v[132:133], v[196:197]
    v_pk_fma_f32 v[164:165], v[196:197], v[212:213], v[164:165]
    v_pk_add_f32 v[134:135], v[134:135], v[198:199]
    v_pk_fma_f32 v[166:167], v[198:199], v[214:215], v[166:167]
    v_pk_add_f32 v[136:137], v[136:137], v[200:201]
    v_pk_fma_f32 v[168:169], v[200:201], v[216:217], v[168:169]
    v_pk_add_f32 v[138:139], v[138:139], v[202:203]
    v_pk_fma_f32 v[170:171], v[202:203], v[218:219], v[170:171]
    v_pk_add_f32 v[140:141], v[140:141], v[204:205]
    v_pk_fma_f32 v[172:173], v[204:205], v[220:221], v[172:173]
    v_pk_add_f32 v[142:143], v[142:143], v[206:207]
    v_pk_fma_f32 v[174:175], v[206:207], v[222:223], v[174:175]
    v_mfma_f32_32x32x8_bf16 v[192:207], v[12:13], v[10:11], v[96:111]
    buffer_load_dwordx4 v4, s[4:7], s28 offen  lds
    v_exp_f32 v224, v224
    v_exp_f32 v225, v225
    v_exp_f32 v226, v226
    v_mfma_f32_32x32x16_bf16 v[192:207], v[32:35], v[16:19], v[192:207]
    buffer_load_dwordx4 v5, s[4:7], s29 offen offset:1040  lds
    v_exp_f32 v227, v227
    v_exp_f32 v228, v228
    v_exp_f32 v229, v229
    v_mfma_f32_32x32x16_bf16 v[208:223], v[64:67], v[16:19], 0
    buffer_load_dwordx4 v6, s[4:7], s30 offen offset:2080  lds
    v_exp_f32 v230, v230
    v_exp_f32 v231, v231
    v_exp_f32 v232, v232
    v_mfma_f32_32x32x16_bf16 v[192:207], v[36:39], v[20:23], v[192:207]
    buffer_load_dwordx4 v7, s[4:7], 0 offen offset:3120  lds
    v_exp_f32 v233, v233
    v_exp_f32 v234, v234
    v_exp_f32 v235, v235
    v_mfma_f32_32x32x16_bf16 v[208:223], v[68:71], v[20:23], v[208:223]
    v_exp_f32 v236, v236
    v_exp_f32 v237, v237
    v_exp_f32 v238, v238
    v_exp_f32 v239, v239
    v_add_u32 v2, s42, v1
    v_pk_add_f32 v[224:225], v[224:225], s[34:35]
    v_pk_add_f32 v[226:227], v[226:227], s[34:35]
    v_pk_add_f32 v[228:229], v[228:229], s[34:35]
    v_pk_add_f32 v[230:231], v[230:231], s[34:35]
    v_pk_add_f32 v[232:233], v[232:233], s[34:35]
    v_pk_add_f32 v[234:235], v[234:235], s[34:35]
    v_pk_add_f32 v[236:237], v[236:237], s[34:35]
    v_pk_add_f32 v[238:239], v[238:239], s[34:35]
    v_mfma_f32_32x32x16_bf16 v[192:207], v[40:43], v[24:27], v[192:207]
    v_rcp_f32 v224, v224
    v_rcp_f32 v225, v225
    v_rcp_f32 v226, v226
    v_mfma_f32_32x32x16_bf16 v[208:223], v[72:75], v[24:27], v[208:223]
    v_rcp_f32 v227, v227
    v_rcp_f32 v228, v228
    v_rcp_f32 v229, v229
    v_mfma_f32_32x32x16_bf16 v[192:207], v[44:47], v[28:31], v[192:207]
    v_rcp_f32 v230, v230
    v_rcp_f32 v231, v231
    v_rcp_f32 v232, v232
    v_mfma_f32_32x32x16_bf16 v[208:223], v[76:79], v[28:31], v[208:223]
    s_sub_u32 s43, s43, 1
    v_rcp_f32 v233, v233
    v_rcp_f32 v234, v234
    v_rcp_f32 v235, v235
    v_rcp_f32 v236, v236
    v_rcp_f32 v237, v237
    v_rcp_f32 v238, v238
    v_rcp_f32 v239, v239
    v_pk_add_f32 v[144:145], v[144:145], v[224:225]
    v_pk_fma_f32 v[176:177], v[224:225], v[240:241], v[176:177]
    v_pk_add_f32 v[146:147], v[146:147], v[226:227]
    v_pk_fma_f32 v[178:179], v[226:227], v[242:243], v[178:179]
    v_pk_add_f32 v[148:149], v[148:149], v[228:229]
    v_pk_fma_f32 v[180:181], v[228:229], v[244:245], v[180:181]
    v_pk_add_f32 v[150:151], v[150:151], v[230:231]
    v_pk_fma_f32 v[182:183], v[230:231], v[246:247], v[182:183]
    v_pk_add_f32 v[152:153], v[152:153], v[232:233]
    v_pk_fma_f32 v[184:185], v[232:233], v[248:249], v[184:185]
    v_pk_add_f32 v[154:155], v[154:155], v[234:235]
    v_pk_fma_f32 v[186:187], v[234:235], v[250:251], v[186:187]
    v_pk_add_f32 v[156:157], v[156:157], v[236:237]
    v_pk_fma_f32 v[188:189], v[236:237], v[252:253], v[188:189]
    v_pk_add_f32 v[158:159], v[158:159], v[238:239]
    v_pk_fma_f32 v[190:191], v[238:239], v[254:255], v[190:191]
    s_cbranch_scc0 K2_LOOP
K2_LOOPEND:
    v_mbcnt_lo_u32_b32 v4, -1, 0
    v_mbcnt_hi_u32_b32 v4, -1, v4
    v_lshlrev_b32 v5, 4, v4
    v_subrev_u32 v9, 128, v9
    ds_read_b32 v0, v9
    v_subrev_u32 v8, 512, v8
    ds_read_b128 v[96:99], v8
    v_add_u32 v100, s40, v5
    v_add_u32 v101, s40, v1
    s_mov_b64 s[54:55], -1
    ds_read_b128 v[32:35], v5 offset:51200
    ds_read_b128 v[36:39], v5 offset:52224
    ds_read_b128 v[40:43], v5 offset:53248
    ds_read_b128 v[44:47], v5 offset:54272
    ds_read_b128 v[48:51], v5 offset:55296
    ds_read_b128 v[52:55], v5 offset:56320
    ds_read_b128 v[56:59], v5 offset:57344
    ds_read_b128 v[60:63], v5 offset:58368
    s_mov_b32 s48, 0
    s_cmp_ge_u32 s44, 3
    s_cbranch_scc1 K2_NOCOMB
    s_mov_b32 s48, 8
    s_mov_b32 s55, 0
    s_cmp_eq_u32 s33, 0
    s_cbranch_scc1 K2_SPLITEP
    v_add_f32_dpp v128, v128, v128 row_ror:8 row_mask:0xf bank_mask:0xf
    v_add_f32_dpp v129, v129, v129 row_ror:8 row_mask:0xf bank_mask:0xf
    v_add_f32_dpp v130, v130, v130 row_ror:8 row_mask:0xf bank_mask:0xf
    v_add_f32_dpp v131, v131, v131 row_ror:8 row_mask:0xf bank_mask:0xf
    v_add_f32_dpp v132, v132, v132 row_ror:8 row_mask:0xf bank_mask:0xf
    v_add_f32_dpp v133, v133, v133 row_ror:8 row_mask:0xf bank_mask:0xf
    v_add_f32_dpp v134, v134, v134 row_ror:8 row_mask:0xf bank_mask:0xf
    v_add_f32_dpp v135, v135, v135 row_ror:8 row_mask:0xf bank_mask:0xf
    v_add_f32_dpp v136, v136, v136 row_ror:8 row_mask:0xf bank_mask:0xf
    v_add_f32_dpp v137, v137, v137 row_ror:8 row_mask:0xf bank_mask:0xf
    v_add_f32_dpp v138, v138, v138 row_ror:8 row_mask:0xf bank_mask:0xf
    v_add_f32_dpp v139, v139, v139 row_ror:8 row_mask:0xf bank_mask:0xf
    v_add_f32_dpp v140, v140, v140 row_ror:8 row_mask:0xf bank_mask:0xf
    v_add_f32_dpp v141, v141, v141 row_ror:8 row_mask:0xf bank_mask:0xf
    v_add_f32_dpp v142, v142, v142 row_ror:8 row_mask:0xf bank_mask:0xf
    v_add_f32_dpp v143, v143, v143 row_ror:8 row_mask:0xf bank_mask:0xf
    v_add_f32_dpp v144, v144, v144 row_ror:8 row_mask:0xf bank_mask:0xf
    v_add_f32_dpp v145, v145, v145 row_ror:8 row_mask:0xf bank_mask:0xf
    v_add_f32_dpp v146, v146, v146 row_ror:8 row_mask:0xf bank_mask:0xf
    v_add_f32_dpp v147, v147, v147 row_ror:8 row_mask:0xf bank_mask:0xf
    v_add_f32_dpp v148, v148, v148 row_ror:8 row_mask:0xf bank_mask:0xf
    v_add_f32_dpp v149, v149, v149 row_ror:8 row_mask:0xf bank_mask:0xf
    v_add_f32_dpp v150, v150, v150 row_ror:8 row_mask:0xf bank_mask:0xf
    v_add_f32_dpp v151, v151, v151 row_ror:8 row_mask:0xf bank_mask:0xf
    v_add_f32_dpp v152, v152, v152 row_ror:8 row_mask:0xf bank_mask:0xf
    v_add_f32_dpp v153, v153, v153 row_ror:8 row_mask:0xf bank_mask:0xf
    v_add_f32_dpp v154, v154, v154 row_ror:8 row_mask:0xf bank_mask:0xf
    v_add_f32_dpp v155, v155, v155 row_ror:8 row_mask:0xf bank_mask:0xf
    v_add_f32_dpp v156, v156, v156 row_ror:8 row_mask:0xf bank_mask:0xf
    v_add_f32_dpp v157, v157, v157 row_ror:8 row_mask:0xf bank_mask:0xf
    v_add_f32_dpp v158, v158, v158 row_ror:8 row_mask:0xf bank_mask:0xf
    v_add_f32_dpp v159, v159, v159 row_ror:8 row_mask:0xf bank_mask:0xf
    v_add_f32_dpp v160, v160, v160 row_ror:8 row_mask:0xf bank_mask:0xf
    v_add_f32_dpp v161, v161, v161 row_ror:8 row_mask:0xf bank_mask:0xf
    v_add_f32_dpp v162, v162, v162 row_ror:8 row_mask:0xf bank_mask:0xf
    v_add_f32_dpp v163, v163, v163 row_ror:8 row_mask:0xf bank_mask:0xf
    v_add_f32_dpp v164, v164, v164 row_ror:8 row_mask:0xf bank_mask:0xf
    v_add_f32_dpp v165, v165, v165 row_ror:8 row_mask:0xf bank_mask:0xf
    v_add_f32_dpp v166, v166, v166 row_ror:8 row_mask:0xf bank_mask:0xf
    v_add_f32_dpp v167, v167, v167 row_ror:8 row_mask:0xf bank_mask:0xf
    v_add_f32_dpp v168, v168, v168 row_ror:8 row_mask:0xf bank_mask:0xf
    v_add_f32_dpp v169, v169, v169 row_ror:8 row_mask:0xf bank_mask:0xf
    v_add_f32_dpp v170, v170, v170 row_ror:8 row_mask:0xf bank_mask:0xf
    v_add_f32_dpp v171, v171, v171 row_ror:8 row_mask:0xf bank_mask:0xf
    v_add_f32_dpp v172, v172, v172 row_ror:8 row_mask:0xf bank_mask:0xf
    v_add_f32_dpp v173, v173, v173 row_ror:8 row_mask:0xf bank_mask:0xf
    v_add_f32_dpp v174, v174, v174 row_ror:8 row_mask:0xf bank_mask:0xf
    v_add_f32_dpp v175, v175, v175 row_ror:8 row_mask:0xf bank_mask:0xf
    v_add_f32_dpp v176, v176, v176 row_ror:8 row_mask:0xf bank_mask:0xf
    v_add_f32_dpp v177, v177, v177 row_ror:8 row_mask:0xf bank_mask:0xf
    v_add_f32_dpp v178, v178, v178 row_ror:8 row_mask:0xf bank_mask:0xf
    v_add_f32_dpp v179, v179, v179 row_ror:8 row_mask:0xf bank_mask:0xf
    v_add_f32_dpp v180, v180, v180 row_ror:8 row_mask:0xf bank_mask:0xf
    v_add_f32_dpp v181, v181, v181 row_ror:8 row_mask:0xf bank_mask:0xf
    v_add_f32_dpp v182, v182, v182 row_ror:8 row_mask:0xf bank_mask:0xf
    v_add_f32_dpp v183, v183, v183 row_ror:8 row_mask:0xf bank_mask:0xf
    v_add_f32_dpp v184, v184, v184 row_ror:8 row_mask:0xf bank_mask:0xf
    v_add_f32_dpp v185, v185, v185 row_ror:8 row_mask:0xf bank_mask:0xf
    v_add_f32_dpp v186, v186, v186 row_ror:8 row_mask:0xf bank_mask:0xf
    v_add_f32_dpp v187, v187, v187 row_ror:8 row_mask:0xf bank_mask:0xf
    v_add_f32_dpp v188, v188, v188 row_ror:8 row_mask:0xf bank_mask:0xf
    v_add_f32_dpp v189, v189, v189 row_ror:8 row_mask:0xf bank_mask:0xf
    v_add_f32_dpp v190, v190, v190 row_ror:8 row_mask:0xf bank_mask:0xf
    v_add_f32_dpp v191, v191, v191 row_ror:8 row_mask:0xf bank_mask:0xf
    s_cmp_lg_u32 s44, 0
    s_cbranch_scc1 K2_NOCOMB
    s_mov_b32 s48, 12
    s_mov_b32 s54, 0xffff
    v_add_f32_dpp v128, v128, v128 row_ror:4 row_mask:0xf bank_mask:0xf
    v_add_f32_dpp v129, v129, v129 row_ror:4 row_mask:0xf bank_mask:0xf
    v_add_f32_dpp v130, v130, v130 row_ror:4 row_mask:0xf bank_mask:0xf
    v_add_f32_dpp v131, v131, v131 row_ror:4 row_mask:0xf bank_mask:0xf
    v_add_f32_dpp v132, v132, v132 row_ror:4 row_mask:0xf bank_mask:0xf
    v_add_f32_dpp v133, v133, v133 row_ror:4 row_mask:0xf bank_mask:0xf
    v_add_f32_dpp v134, v134, v134 row_ror:4 row_mask:0xf bank_mask:0xf
    v_add_f32_dpp v135, v135, v135 row_ror:4 row_mask:0xf bank_mask:0xf
    v_add_f32_dpp v136, v136, v136 row_ror:4 row_mask:0xf bank_mask:0xf
    v_add_f32_dpp v137, v137, v137 row_ror:4 row_mask:0xf bank_mask:0xf
    v_add_f32_dpp v138, v138, v138 row_ror:4 row_mask:0xf bank_mask:0xf
    v_add_f32_dpp v139, v139, v139 row_ror:4 row_mask:0xf bank_mask:0xf
    v_add_f32_dpp v140, v140, v140 row_ror:4 row_mask:0xf bank_mask:0xf
    v_add_f32_dpp v141, v141, v141 row_ror:4 row_mask:0xf bank_mask:0xf
    v_add_f32_dpp v142, v142, v142 row_ror:4 row_mask:0xf bank_mask:0xf
    v_add_f32_dpp v143, v143, v143 row_ror:4 row_mask:0xf bank_mask:0xf
    v_add_f32_dpp v144, v144, v144 row_ror:4 row_mask:0xf bank_mask:0xf
    v_add_f32_dpp v145, v145, v145 row_ror:4 row_mask:0xf bank_mask:0xf
    v_add_f32_dpp v146, v146, v146 row_ror:4 row_mask:0xf bank_mask:0xf
    v_add_f32_dpp v147, v147, v147 row_ror:4 row_mask:0xf bank_mask:0xf
    v_add_f32_dpp v148, v148, v148 row_ror:4 row_mask:0xf bank_mask:0xf
    v_add_f32_dpp v149, v149, v149 row_ror:4 row_mask:0xf bank_mask:0xf
    v_add_f32_dpp v150, v150, v150 row_ror:4 row_mask:0xf bank_mask:0xf
    v_add_f32_dpp v151, v151, v151 row_ror:4 row_mask:0xf bank_mask:0xf
    v_add_f32_dpp v152, v152, v152 row_ror:4 row_mask:0xf bank_mask:0xf
    v_add_f32_dpp v153, v153, v153 row_ror:4 row_mask:0xf bank_mask:0xf
    v_add_f32_dpp v154, v154, v154 row_ror:4 row_mask:0xf bank_mask:0xf
    v_add_f32_dpp v155, v155, v155 row_ror:4 row_mask:0xf bank_mask:0xf
    v_add_f32_dpp v156, v156, v156 row_ror:4 row_mask:0xf bank_mask:0xf
    v_add_f32_dpp v157, v157, v157 row_ror:4 row_mask:0xf bank_mask:0xf
    v_add_f32_dpp v158, v158, v158 row_ror:4 row_mask:0xf bank_mask:0xf
    v_add_f32_dpp v159, v159, v159 row_ror:4 row_mask:0xf bank_mask:0xf
    v_add_f32_dpp v160, v160, v160 row_ror:4 row_mask:0xf bank_mask:0xf
    v_add_f32_dpp v161, v161, v161 row_ror:4 row_mask:0xf bank_mask:0xf
    v_add_f32_dpp v162, v162, v162 row_ror:4 row_mask:0xf bank_mask:0xf
    v_add_f32_dpp v163, v163, v163 row_ror:4 row_mask:0xf bank_mask:0xf
    v_add_f32_dpp v164, v164, v164 row_ror:4 row_mask:0xf bank_mask:0xf
    v_add_f32_dpp v165, v165, v165 row_ror:4 row_mask:0xf bank_mask:0xf
    v_add_f32_dpp v166, v166, v166 row_ror:4 row_mask:0xf bank_mask:0xf
    v_add_f32_dpp v167, v167, v167 row_ror:4 row_mask:0xf bank_mask:0xf
    v_add_f32_dpp v168, v168, v168 row_ror:4 row_mask:0xf bank_mask:0xf
    v_add_f32_dpp v169, v169, v169 row_ror:4 row_mask:0xf bank_mask:0xf
    v_add_f32_dpp v170, v170, v170 row_ror:4 row_mask:0xf bank_mask:0xf
    v_add_f32_dpp v171, v171, v171 row_ror:4 row_mask:0xf bank_mask:0xf
    v_add_f32_dpp v172, v172, v172 row_ror:4 row_mask:0xf bank_mask:0xf
    v_add_f32_dpp v173, v173, v173 row_ror:4 row_mask:0xf bank_mask:0xf
    v_add_f32_dpp v174, v174, v174 row_ror:4 row_mask:0xf bank_mask:0xf
    v_add_f32_dpp v175, v175, v175 row_ror:4 row_mask:0xf bank_mask:0xf
    v_add_f32_dpp v176, v176, v176 row_ror:4 row_mask:0xf bank_mask:0xf
    v_add_f32_dpp v177, v177, v177 row_ror:4 row_mask:0xf bank_mask:0xf
    v_add_f32_dpp v178, v178, v178 row_ror:4 row_mask:0xf bank_mask:0xf
    v_add_f32_dpp v179, v179, v179 row_ror:4 row_mask:0xf bank_mask:0xf
    v_add_f32_dpp v180, v180, v180 row_ror:4 row_mask:0xf bank_mask:0xf
    v_add_f32_dpp v181, v181, v181 row_ror:4 row_mask:0xf bank_mask:0xf
    v_add_f32_dpp v182, v182, v182 row_ror:4 row_mask:0xf bank_mask:0xf
    v_add_f32_dpp v183, v183, v183 row_ror:4 row_mask:0xf bank_mask:0xf
    v_add_f32_dpp v184, v184, v184 row_ror:4 row_mask:0xf bank_mask:0xf
    v_add_f32_dpp v185, v185, v185 row_ror:4 row_mask:0xf bank_mask:0xf
    v_add_f32_dpp v186, v186, v186 row_ror:4 row_mask:0xf bank_mask:0xf
    v_add_f32_dpp v187, v187, v187 row_ror:4 row_mask:0xf bank_mask:0xf
    v_add_f32_dpp v188, v188, v188 row_ror:4 row_mask:0xf bank_mask:0xf
    v_add_f32_dpp v189, v189, v189 row_ror:4 row_mask:0xf bank_mask:0xf
    v_add_f32_dpp v190, v190, v190 row_ror:4 row_mask:0xf bank_mask:0xf
    v_add_f32_dpp v191, v191, v191 row_ror:4 row_mask:0xf bank_mask:0xf
K2_NOCOMB:
    v_and_b32 v6, s48, v4
    v_cmp_eq_u32 vcc, 0, v6
    v_mov_b32 v7, 0xffff
    v_lshrrev_b32 v4, 5, v4
    s_mov_b32 s49, 0xffff0000
    v_lshlrev_b32 v240, 16, v24
    v_and_b32 v241, s49, v24
    v_lshlrev_b32 v242, 16, v25
    v_and_b32 v243, s49, v25
    v_lshlrev_b32 v244, 16, v26
    v_and_b32 v245, s49, v26
    v_lshlrev_b32 v246, 16, v27
    v_and_b32 v247, s49, v27
    v_lshlrev_b32 v248, 16, v28
    v_and_b32 v249, s49, v28
    v_lshlrev_b32 v250, 16, v29
    v_and_b32 v251, s49, v29
    v_lshlrev_b32 v252, 16, v30
    v_and_b32 v253, s49, v30
    v_lshlrev_b32 v254, 16, v31
    v_and_b32 v255, s49, v31
    v_lshlrev_b32 v208, 16, v16
    v_and_b32 v209, s49, v16
    v_lshlrev_b32 v210, 16, v17
    v_and_b32 v211, s49, v17
    v_lshlrev_b32 v212, 16, v18
    v_and_b32 v213, s49, v18
    v_lshlrev_b32 v214, 16, v19
    v_and_b32 v215, s49, v19
    v_lshlrev_b32 v216, 16, v20
    v_and_b32 v217, s49, v20
    v_lshlrev_b32 v218, 16, v21
    v_and_b32 v219, s49, v21
    v_lshlrev_b32 v220, 16, v22
    v_and_b32 v221, s49, v22
    v_lshlrev_b32 v222, 16, v23
    v_and_b32 v223, s49, v23
    s_waitcnt lgkmcnt(0)
    v_cndmask_b32 v6, v7, v0, vcc
    s_cmp_lg_u32 s33, 0
    s_cbranch_scc1 K2_STOREACC
    s_mov_b32 s52, 0x358637bd
    s_mov_b32 s53, 0x358637bd
    v_lshlrev_b32 v4, 6, v4
    v_lshl_add_u32 v4, v6, 7, v4
    v_mfma_f32_32x32x16_bf16 v[192:207], v[32:35], v[16:19], v[208:223]
    v_rcp_f32 v128, v128
    v_rcp_f32 v129, v129
    v_rcp_f32 v130, v130
    v_mfma_f32_32x32x16_bf16 v[224:239], v[48:51], v[16:19], v[240:255]
    v_rcp_f32 v131, v131
    v_rcp_f32 v132, v132
    v_rcp_f32 v133, v133
    v_mfma_f32_32x32x16_bf16 v[192:207], v[36:39], v[20:23], v[192:207]
    v_rcp_f32 v134, v134
    v_rcp_f32 v135, v135
    v_rcp_f32 v136, v136
    v_mfma_f32_32x32x16_bf16 v[224:239], v[52:55], v[20:23], v[224:239]
    v_rcp_f32 v137, v137
    v_rcp_f32 v138, v138
    v_rcp_f32 v139, v139
    v_mfma_f32_32x32x16_bf16 v[192:207], v[40:43], v[24:27], v[192:207]
    v_rcp_f32 v140, v140
    v_rcp_f32 v141, v141
    v_rcp_f32 v142, v142
    v_mfma_f32_32x32x16_bf16 v[224:239], v[56:59], v[24:27], v[224:239]
    v_rcp_f32 v143, v143
    v_rcp_f32 v144, v144
    v_rcp_f32 v145, v145
    v_mfma_f32_32x32x16_bf16 v[192:207], v[44:47], v[28:31], v[192:207]
    v_rcp_f32 v146, v146
    v_rcp_f32 v147, v147
    v_rcp_f32 v148, v148
    v_mfma_f32_32x32x16_bf16 v[224:239], v[60:63], v[28:31], v[224:239]
    v_rcp_f32 v149, v149
    v_rcp_f32 v150, v150
    v_rcp_f32 v151, v151
    v_rcp_f32 v152, v152
    v_rcp_f32 v153, v153
    v_rcp_f32 v154, v154
    v_rcp_f32 v155, v155
    v_rcp_f32 v156, v156
    v_rcp_f32 v157, v157
    v_rcp_f32 v158, v158
    v_rcp_f32 v159, v159
    s_mov_b32 s49, 0xffff0000
    s_nop 0
    v_pk_fma_f32 v[192:193], v[160:161], v[128:129], v[192:193]
    v_pk_fma_f32 v[194:195], v[162:163], v[130:131], v[194:195]
    v_pk_fma_f32 v[196:197], v[164:165], v[132:133], v[196:197]
    v_pk_fma_f32 v[198:199], v[166:167], v[134:135], v[198:199]
    v_pk_fma_f32 v[200:201], v[168:169], v[136:137], v[200:201]
    v_pk_fma_f32 v[202:203], v[170:171], v[138:139], v[202:203]
    v_pk_fma_f32 v[204:205], v[172:173], v[140:141], v[204:205]
    v_pk_fma_f32 v[206:207], v[174:175], v[142:143], v[206:207]
    v_pk_fma_f32 v[224:225], v[176:177], v[144:145], v[224:225]
    v_pk_fma_f32 v[226:227], v[178:179], v[146:147], v[226:227]
    v_pk_fma_f32 v[228:229], v[180:181], v[148:149], v[228:229]
    v_pk_fma_f32 v[230:231], v[182:183], v[150:151], v[230:231]
    v_pk_fma_f32 v[232:233], v[184:185], v[152:153], v[232:233]
    v_pk_fma_f32 v[234:235], v[186:187], v[154:155], v[234:235]
    v_pk_fma_f32 v[236:237], v[188:189], v[156:157], v[236:237]
    v_pk_fma_f32 v[238:239], v[190:191], v[158:159], v[238:239]
    v_max_f32 v192, v208, v192
    v_max_f32 v193, v209, v193
    v_cvt_pk_bf16_f32 v128, v192, v193
    v_max_f32 v194, v210, v194
    v_max_f32 v195, v211, v195
    v_cvt_pk_bf16_f32 v129, v194, v195
    v_max_f32 v196, v212, v196
    v_max_f32 v197, v213, v197
    v_cvt_pk_bf16_f32 v130, v196, v197
    v_max_f32 v198, v214, v198
    v_max_f32 v199, v215, v199
    v_cvt_pk_bf16_f32 v131, v198, v199
    s_waitcnt vmcnt(0)
    ds_write_b128 v101, v[128:131]
    v_max_f32 v200, v216, v200
    v_max_f32 v201, v217, v201
    v_cvt_pk_bf16_f32 v132, v200, v201
    v_max_f32 v202, v218, v202
    v_max_f32 v203, v219, v203
    v_cvt_pk_bf16_f32 v133, v202, v203
    v_max_f32 v204, v220, v204
    v_max_f32 v205, v221, v205
    v_cvt_pk_bf16_f32 v134, v204, v205
    v_max_f32 v206, v222, v206
    v_max_f32 v207, v223, v207
    v_cvt_pk_bf16_f32 v135, v206, v207
    ds_write_b128 v101, v[132:135] offset:16
    v_max_f32 v224, v240, v224
    v_max_f32 v225, v241, v225
    v_cvt_pk_bf16_f32 v136, v224, v225
    v_max_f32 v226, v242, v226
    v_max_f32 v227, v243, v227
    v_cvt_pk_bf16_f32 v137, v226, v227
    v_max_f32 v228, v244, v228
    v_max_f32 v229, v245, v229
    v_cvt_pk_bf16_f32 v138, v228, v229
    v_max_f32 v230, v246, v230
    v_max_f32 v231, v247, v231
    v_cvt_pk_bf16_f32 v139, v230, v231
    ds_write_b128 v101, v[136:139] offset:32
    v_max_f32 v232, v248, v232
    v_max_f32 v233, v249, v233
    v_cvt_pk_bf16_f32 v140, v232, v233
    v_max_f32 v234, v250, v234
    v_max_f32 v235, v251, v235
    v_cvt_pk_bf16_f32 v141, v234, v235
    v_max_f32 v236, v252, v236
    v_max_f32 v237, v253, v237
    v_cvt_pk_bf16_f32 v142, v236, v237
    v_max_f32 v238, v254, v238
    v_max_f32 v239, v255, v239
    v_cvt_pk_bf16_f32 v143, v238, v239
    ds_write_b128 v101, v[140:143] offset:48
K2_OUT:
    s_mov_b64 exec, s[54:55]
    ds_read_b128 v[104:107], v100
    ds_read_b128 v[108:111], v100 offset:1040
    ds_read_b128 v[112:115], v100 offset:2080
    ds_read_b128 v[116:119], v100 offset:3120
    v_mad_u32_u16 v96, v96, s31, v3
    v_mad_u32_u16 v97, v97, s31, v3
    v_mad_u32_u16 v98, v98, s31, v3
    v_mad_u32_u16 v99, v99, s31, v3
    s_waitcnt lgkmcnt(3)
    buffer_store_dwordx4 v[104:107], v96, s[20:23], 0 offen sc1
    s_waitcnt lgkmcnt(2)
    buffer_store_dwordx4 v[108:111], v97, s[20:23], 0 offen sc1
    s_waitcnt lgkmcnt(1)
    buffer_store_dwordx4 v[112:115], v98, s[20:23], 0 offen sc1
    s_waitcnt lgkmcnt(0)
    buffer_store_dwordx4 v[116:119], v99, s[20:23], 0 offen sc1
K2_END:
    s_endpgm
K2_SPLITEP:
    v_add_u32 v102, 32, v101
    s_mov_b32 s50, 0xff00ff00
    s_mov_b32 s51, 0xff00ff00
    s_mov_b32 s52, 0x358637bd
    s_mov_b32 s53, 0x358637bd
    s_mov_b32 s49, 0xffff0000
    v_mov_b32_dpp v101, v102 row_ror:8 row_mask:0xf bank_mask:0xc
    v_add_f32_dpp v128, v128, v128 row_ror:8 row_mask:0xf bank_mask:0x3
    v_add_f32_dpp v128, v144, v144 row_ror:8 row_mask:0xf bank_mask:0xc
    v_add_f32_dpp v129, v129, v129 row_ror:8 row_mask:0xf bank_mask:0x3
    v_add_f32_dpp v129, v145, v145 row_ror:8 row_mask:0xf bank_mask:0xc
    v_add_f32_dpp v130, v130, v130 row_ror:8 row_mask:0xf bank_mask:0x3
    v_add_f32_dpp v130, v146, v146 row_ror:8 row_mask:0xf bank_mask:0xc
    v_add_f32_dpp v131, v131, v131 row_ror:8 row_mask:0xf bank_mask:0x3
    v_add_f32_dpp v131, v147, v147 row_ror:8 row_mask:0xf bank_mask:0xc
    v_add_f32_dpp v132, v132, v132 row_ror:8 row_mask:0xf bank_mask:0x3
    v_add_f32_dpp v132, v148, v148 row_ror:8 row_mask:0xf bank_mask:0xc
    v_add_f32_dpp v133, v133, v133 row_ror:8 row_mask:0xf bank_mask:0x3
    v_add_f32_dpp v133, v149, v149 row_ror:8 row_mask:0xf bank_mask:0xc
    v_add_f32_dpp v134, v134, v134 row_ror:8 row_mask:0xf bank_mask:0x3
    v_add_f32_dpp v134, v150, v150 row_ror:8 row_mask:0xf bank_mask:0xc
    v_add_f32_dpp v135, v135, v135 row_ror:8 row_mask:0xf bank_mask:0x3
    v_add_f32_dpp v135, v151, v151 row_ror:8 row_mask:0xf bank_mask:0xc
    s_waitcnt lgkmcnt(0)
    v_mfma_f32_32x32x16_bf16 v[192:207], v[32:35], v[16:19], 0
    v_add_f32_dpp v136, v136, v136 row_ror:8 row_mask:0xf bank_mask:0x3
    v_add_f32_dpp v136, v152, v152 row_ror:8 row_mask:0xf bank_mask:0xc
    v_add_f32_dpp v137, v137, v137 row_ror:8 row_mask:0xf bank_mask:0x3
    v_add_f32_dpp v137, v153, v153 row_ror:8 row_mask:0xf bank_mask:0xc
    v_add_f32_dpp v138, v138, v138 row_ror:8 row_mask:0xf bank_mask:0x3
    v_add_f32_dpp v138, v154, v154 row_ror:8 row_mask:0xf bank_mask:0xc
    v_mfma_f32_32x32x16_bf16 v[224:239], v[48:51], v[16:19], 0
    v_add_f32_dpp v139, v139, v139 row_ror:8 row_mask:0xf bank_mask:0x3
    v_add_f32_dpp v139, v155, v155 row_ror:8 row_mask:0xf bank_mask:0xc
    v_add_f32_dpp v140, v140, v140 row_ror:8 row_mask:0xf bank_mask:0x3
    v_add_f32_dpp v140, v156, v156 row_ror:8 row_mask:0xf bank_mask:0xc
    v_add_f32_dpp v141, v141, v141 row_ror:8 row_mask:0xf bank_mask:0x3
    v_add_f32_dpp v141, v157, v157 row_ror:8 row_mask:0xf bank_mask:0xc
    v_mfma_f32_32x32x16_bf16 v[192:207], v[36:39], v[20:23], v[192:207]
    v_add_f32_dpp v142, v142, v142 row_ror:8 row_mask:0xf bank_mask:0x3
    v_add_f32_dpp v142, v158, v158 row_ror:8 row_mask:0xf bank_mask:0xc
    v_add_f32_dpp v143, v143, v143 row_ror:8 row_mask:0xf bank_mask:0x3
    v_add_f32_dpp v143, v159, v159 row_ror:8 row_mask:0xf bank_mask:0xc
    v_add_f32_dpp v160, v160, v160 row_ror:8 row_mask:0xf bank_mask:0x3
    v_add_f32_dpp v160, v176, v176 row_ror:8 row_mask:0xf bank_mask:0xc
    v_mfma_f32_32x32x16_bf16 v[224:239], v[52:55], v[20:23], v[224:239]
    v_add_f32_dpp v161, v161, v161 row_ror:8 row_mask:0xf bank_mask:0x3
    v_add_f32_dpp v161, v177, v177 row_ror:8 row_mask:0xf bank_mask:0xc
    v_add_f32_dpp v162, v162, v162 row_ror:8 row_mask:0xf bank_mask:0x3
    v_add_f32_dpp v162, v178, v178 row_ror:8 row_mask:0xf bank_mask:0xc
    v_add_f32_dpp v163, v163, v163 row_ror:8 row_mask:0xf bank_mask:0x3
    v_add_f32_dpp v163, v179, v179 row_ror:8 row_mask:0xf bank_mask:0xc
    v_mfma_f32_32x32x16_bf16 v[192:207], v[40:43], v[24:27], v[192:207]
    v_add_f32_dpp v164, v164, v164 row_ror:8 row_mask:0xf bank_mask:0x3
    v_add_f32_dpp v164, v180, v180 row_ror:8 row_mask:0xf bank_mask:0xc
    v_add_f32_dpp v165, v165, v165 row_ror:8 row_mask:0xf bank_mask:0x3
    v_add_f32_dpp v165, v181, v181 row_ror:8 row_mask:0xf bank_mask:0xc
    v_add_f32_dpp v166, v166, v166 row_ror:8 row_mask:0xf bank_mask:0x3
    v_add_f32_dpp v166, v182, v182 row_ror:8 row_mask:0xf bank_mask:0xc
    v_mfma_f32_32x32x16_bf16 v[224:239], v[56:59], v[24:27], v[224:239]
    v_add_f32_dpp v167, v167, v167 row_ror:8 row_mask:0xf bank_mask:0x3
    v_add_f32_dpp v167, v183, v183 row_ror:8 row_mask:0xf bank_mask:0xc
    v_add_f32_dpp v168, v168, v168 row_ror:8 row_mask:0xf bank_mask:0x3
    v_add_f32_dpp v168, v184, v184 row_ror:8 row_mask:0xf bank_mask:0xc
    v_add_f32_dpp v169, v169, v169 row_ror:8 row_mask:0xf bank_mask:0x3
    v_add_f32_dpp v169, v185, v185 row_ror:8 row_mask:0xf bank_mask:0xc
    v_mfma_f32_32x32x16_bf16 v[192:207], v[44:47], v[28:31], v[192:207]
    v_add_f32_dpp v170, v170, v170 row_ror:8 row_mask:0xf bank_mask:0x3
    v_add_f32_dpp v170, v186, v186 row_ror:8 row_mask:0xf bank_mask:0xc
    v_add_f32_dpp v171, v171, v171 row_ror:8 row_mask:0xf bank_mask:0x3
    v_add_f32_dpp v171, v187, v187 row_ror:8 row_mask:0xf bank_mask:0xc
    v_add_f32_dpp v172, v172, v172 row_ror:8 row_mask:0xf bank_mask:0x3
    v_add_f32_dpp v172, v188, v188 row_ror:8 row_mask:0xf bank_mask:0xc
    v_mfma_f32_32x32x16_bf16 v[224:239], v[60:63], v[28:31], v[224:239]
    v_add_f32_dpp v173, v173, v173 row_ror:8 row_mask:0xf bank_mask:0x3
    v_add_f32_dpp v173, v189, v189 row_ror:8 row_mask:0xf bank_mask:0xc
    v_add_f32_dpp v174, v174, v174 row_ror:8 row_mask:0xf bank_mask:0x3
    v_add_f32_dpp v174, v190, v190 row_ror:8 row_mask:0xf bank_mask:0xc
    v_add_f32_dpp v175, v175, v175 row_ror:8 row_mask:0xf bank_mask:0x3
    v_add_f32_dpp v175, v191, v191 row_ror:8 row_mask:0xf bank_mask:0xc
    s_cmp_lg_u32 s44, 0
    s_cbranch_scc1 K2_SPLIT2
    s_mov_b32 s54, 0xffff
    v_add_f32_dpp v128, v128, v128 row_shl:4 row_mask:0xf bank_mask:0x5
    v_add_f32_dpp v129, v129, v129 row_shl:4 row_mask:0xf bank_mask:0x5
    v_add_f32_dpp v130, v130, v130 row_shl:4 row_mask:0xf bank_mask:0x5
    v_add_f32_dpp v131, v131, v131 row_shl:4 row_mask:0xf bank_mask:0x5
    v_add_f32_dpp v132, v132, v132 row_shl:4 row_mask:0xf bank_mask:0x5
    v_add_f32_dpp v133, v133, v133 row_shl:4 row_mask:0xf bank_mask:0x5
    v_add_f32_dpp v134, v134, v134 row_shl:4 row_mask:0xf bank_mask:0x5
    v_add_f32_dpp v135, v135, v135 row_shl:4 row_mask:0xf bank_mask:0x5
    v_add_f32_dpp v136, v136, v136 row_shl:4 row_mask:0xf bank_mask:0x5
    v_add_f32_dpp v137, v137, v137 row_shl:4 row_mask:0xf bank_mask:0x5
    v_add_f32_dpp v138, v138, v138 row_shl:4 row_mask:0xf bank_mask:0x5
    v_add_f32_dpp v139, v139, v139 row_shl:4 row_mask:0xf bank_mask:0x5
    v_add_f32_dpp v140, v140, v140 row_shl:4 row_mask:0xf bank_mask:0x5
    v_add_f32_dpp v141, v141, v141 row_shl:4 row_mask:0xf bank_mask:0x5
    v_add_f32_dpp v142, v142, v142 row_shl:4 row_mask:0xf bank_mask:0x5
    v_add_f32_dpp v143, v143, v143 row_shl:4 row_mask:0xf bank_mask:0x5
    v_add_f32_dpp v160, v160, v160 row_shl:4 row_mask:0xf bank_mask:0x5
    v_add_f32_dpp v161, v161, v161 row_shl:4 row_mask:0xf bank_mask:0x5
    v_add_f32_dpp v162, v162, v162 row_shl:4 row_mask:0xf bank_mask:0x5
    v_add_f32_dpp v163, v163, v163 row_shl:4 row_mask:0xf bank_mask:0x5
    v_add_f32_dpp v164, v164, v164 row_shl:4 row_mask:0xf bank_mask:0x5
    v_add_f32_dpp v165, v165, v165 row_shl:4 row_mask:0xf bank_mask:0x5
    v_add_f32_dpp v166, v166, v166 row_shl:4 row_mask:0xf bank_mask:0x5
    v_add_f32_dpp v167, v167, v167 row_shl:4 row_mask:0xf bank_mask:0x5
    v_add_f32_dpp v168, v168, v168 row_shl:4 row_mask:0xf bank_mask:0x5
    v_add_f32_dpp v169, v169, v169 row_shl:4 row_mask:0xf bank_mask:0x5
    v_add_f32_dpp v170, v170, v170 row_shl:4 row_mask:0xf bank_mask:0x5
    v_add_f32_dpp v171, v171, v171 row_shl:4 row_mask:0xf bank_mask:0x5
    v_add_f32_dpp v172, v172, v172 row_shl:4 row_mask:0xf bank_mask:0x5
    v_add_f32_dpp v173, v173, v173 row_shl:4 row_mask:0xf bank_mask:0x5
    v_add_f32_dpp v174, v174, v174 row_shl:4 row_mask:0xf bank_mask:0x5
    v_add_f32_dpp v175, v175, v175 row_shl:4 row_mask:0xf bank_mask:0x5
K2_SPLIT2:
    v_cndmask_b32 v144, v16, v24, s[50:51]
    v_cndmask_b32 v145, v17, v25, s[50:51]
    v_cndmask_b32 v146, v18, v26, s[50:51]
    v_cndmask_b32 v147, v19, v27, s[50:51]
    v_cndmask_b32 v148, v20, v28, s[50:51]
    v_cndmask_b32 v149, v21, v29, s[50:51]
    v_cndmask_b32 v150, v22, v30, s[50:51]
    v_cndmask_b32 v151, v23, v31, s[50:51]
    v_rcp_f32 v128, v128
    v_rcp_f32 v129, v129
    v_rcp_f32 v130, v130
    v_rcp_f32 v131, v131
    v_rcp_f32 v132, v132
    v_rcp_f32 v133, v133
    v_rcp_f32 v134, v134
    v_rcp_f32 v135, v135
    v_rcp_f32 v136, v136
    v_rcp_f32 v137, v137
    v_rcp_f32 v138, v138
    v_rcp_f32 v139, v139
    v_rcp_f32 v140, v140
    v_rcp_f32 v141, v141
    v_rcp_f32 v142, v142
    v_rcp_f32 v143, v143
    v_cndmask_b32 v192, v192, v224, s[50:51]
    v_cndmask_b32 v193, v193, v225, s[50:51]
    v_cndmask_b32 v194, v194, v226, s[50:51]
    v_cndmask_b32 v195, v195, v227, s[50:51]
    v_cndmask_b32 v196, v196, v228, s[50:51]
    v_cndmask_b32 v197, v197, v229, s[50:51]
    v_cndmask_b32 v198, v198, v230, s[50:51]
    v_cndmask_b32 v199, v199, v231, s[50:51]
    v_cndmask_b32 v200, v200, v232, s[50:51]
    v_cndmask_b32 v201, v201, v233, s[50:51]
    v_cndmask_b32 v202, v202, v234, s[50:51]
    v_cndmask_b32 v203, v203, v235, s[50:51]
    v_cndmask_b32 v204, v204, v236, s[50:51]
    v_cndmask_b32 v205, v205, v237, s[50:51]
    v_cndmask_b32 v206, v206, v238, s[50:51]
    v_cndmask_b32 v207, v207, v239, s[50:51]
    v_pk_fma_f32 v[192:193], v[160:161], v[128:129], v[192:193]
    v_pk_fma_f32 v[194:195], v[162:163], v[130:131], v[194:195]
    v_pk_fma_f32 v[196:197], v[164:165], v[132:133], v[196:197]
    v_pk_fma_f32 v[198:199], v[166:167], v[134:135], v[198:199]
    v_pk_fma_f32 v[200:201], v[168:169], v[136:137], v[200:201]
    v_pk_fma_f32 v[202:203], v[170:171], v[138:139], v[202:203]
    v_pk_fma_f32 v[204:205], v[172:173], v[140:141], v[204:205]
    v_pk_fma_f32 v[206:207], v[174:175], v[142:143], v[206:207]
    v_lshlrev_b32 v208, 16, v144
    v_and_b32 v209, s49, v144
    v_max_f32 v192, 0, v192
    v_max_f32 v193, 0, v193
    v_pk_add_f32 v[192:193], v[192:193], v[208:209]
    v_cvt_pk_bf16_f32 v128, v192, v193
    v_lshlrev_b32 v210, 16, v145
    v_and_b32 v211, s49, v145
    v_max_f32 v194, 0, v194
    v_max_f32 v195, 0, v195
    v_pk_add_f32 v[194:195], v[194:195], v[210:211]
    v_cvt_pk_bf16_f32 v129, v194, v195
    v_lshlrev_b32 v212, 16, v146
    v_and_b32 v213, s49, v146
    v_max_f32 v196, 0, v196
    v_max_f32 v197, 0, v197
    v_pk_add_f32 v[196:197], v[196:197], v[212:213]
    v_cvt_pk_bf16_f32 v130, v196, v197
    v_lshlrev_b32 v214, 16, v147
    v_and_b32 v215, s49, v147
    v_max_f32 v198, 0, v198
    v_max_f32 v199, 0, v199
    v_pk_add_f32 v[198:199], v[198:199], v[214:215]
    v_cvt_pk_bf16_f32 v131, v198, v199
    s_waitcnt vmcnt(0)
    ds_write_b128 v101, v[128:131]
    v_lshlrev_b32 v216, 16, v148
    v_and_b32 v217, s49, v148
    v_max_f32 v200, 0, v200
    v_max_f32 v201, 0, v201
    v_pk_add_f32 v[200:201], v[200:201], v[216:217]
    v_cvt_pk_bf16_f32 v132, v200, v201
    v_lshlrev_b32 v218, 16, v149
    v_and_b32 v219, s49, v149
    v_max_f32 v202, 0, v202
    v_max_f32 v203, 0, v203
    v_pk_add_f32 v[202:203], v[202:203], v[218:219]
    v_cvt_pk_bf16_f32 v133, v202, v203
    v_lshlrev_b32 v220, 16, v150
    v_and_b32 v221, s49, v150
    v_max_f32 v204, 0, v204
    v_max_f32 v205, 0, v205
    v_pk_add_f32 v[204:205], v[204:205], v[220:221]
    v_cvt_pk_bf16_f32 v134, v204, v205
    v_lshlrev_b32 v222, 16, v151
    v_and_b32 v223, s49, v151
    v_max_f32 v206, 0, v206
    v_max_f32 v207, 0, v207
    v_pk_add_f32 v[206:207], v[206:207], v[222:223]
    v_cvt_pk_bf16_f32 v135, v206, v207
    ds_write_b128 v101, v[132:135] offset:16
    s_branch K2_OUT
K2_FLAGS:
    s_and_b32 s48, s33, 0xff
    s_cbranch_scc0 K2_PEND
    s_movk_i32 s36, 96
    s_mov_b32 s47, 1
    s_branch K2_AGAIN
K2_PEND:
    s_and_b32 s47, s33, 0x200
    s_cbranch_scc0 K2_FLAGSDONE
    s_cmp_eq_u32 s38, 0
    s_cbranch_scc1 K2_AGAIN
    v_cmp_le_u32 vcc, v192, v160
    s_and_b64 s[64:65], s[64:65], vcc
    v_cmp_le_u32 vcc, v193, v161
    s_and_b64 s[66:67], s[66:67], vcc
    v_cmp_le_u32 vcc, v194, v162
    s_and_b64 s[68:69], s[68:69], vcc
    v_cmp_le_u32 vcc, v195, v163
    s_and_b64 s[70:71], s[70:71], vcc
    v_cmp_le_u32 vcc, v196, v164
    s_and_b64 s[72:73], s[72:73], vcc
    v_cmp_le_u32 vcc, v197, v165
    s_and_b64 s[74:75], s[74:75], vcc
    v_cmp_le_u32 vcc, v198, v166
    s_and_b64 s[76:77], s[76:77], vcc
    v_cmp_le_u32 vcc, v199, v167
    s_and_b64 s[78:79], s[78:79], vcc
    v_cmp_le_u32 vcc, v200, v168
    s_and_b64 s[80:81], s[80:81], vcc
    v_cmp_le_u32 vcc, v201, v169
    s_and_b64 s[82:83], s[82:83], vcc
    v_cmp_le_u32 vcc, v202, v170
    s_and_b64 s[84:85], s[84:85], vcc
    v_cmp_le_u32 vcc, v203, v171
    s_and_b64 s[86:87], s[86:87], vcc
    v_cmp_le_u32 vcc, v204, v172
    s_and_b64 s[88:89], s[88:89], vcc
    v_cmp_le_u32 vcc, v205, v173
    s_and_b64 s[90:91], s[90:91], vcc
    v_cmp_le_u32 vcc, v206, v174
    s_and_b64 s[92:93], s[92:93], vcc
    v_cmp_le_u32 vcc, v207, v175
    s_and_b64 s[94:95], s[94:95], vcc
    s_branch K2_FLAGSDONE
K2_X3:
    s_mov_b32 s39, 1
    v_mul_u32_u24 v102, 25728, v22
    v_mov_b32 v104, 0
    v_lshlrev_b32_sdwa v156, 2, v131 dst_sel:DWORD dst_unused:UNUSED_PAD src0_sel:DWORD src1_sel:BYTE_3
    s_cmp_lg_u32 s47, 0
    s_cbranch_scc1 K2_X3K0
    v_cmp_ne_u32 s[88:89], 0, v156
K2_X3K0:
    s_mov_b32 s48, 0
    s_mov_b64 exec, s[88:89]
    buffer_load_dword v220, v186, s[12:15], s48 offen
    ds_add_rtn_u32 v172, v156, v31 offset:59388
    s_mov_b64 exec, -1
    v_cmp_ne_u32 vcc, 0, v156
    s_mov_b32 s48, 0x80808080
    s_and_b32 exec_lo, vcc_lo, s48
    s_and_b32 exec_hi, vcc_hi, s48
    s_cbranch_execz K2_X3N0
    s_mov_b32 s48, 2097152
    buffer_load_dword v103, v102, s[12:15], s48 offen
    s_waitcnt vmcnt(0)
    v_or_b32 v104, v104, v103
K2_X3N0:
    s_mov_b64 exec, -1
    v_lshlrev_b32_sdwa v157, 2, v135 dst_sel:DWORD dst_unused:UNUSED_PAD src0_sel:DWORD src1_sel:BYTE_3
    s_cmp_lg_u32 s47, 0
    s_cbranch_scc1 K2_X3K1
    v_cmp_ne_u32 s[90:91], 0, v157
K2_X3K1:
    s_mov_b32 s48, 524288
    s_mov_b64 exec, s[90:91]
    buffer_load_dword v221, v186, s[12:15], s48 offen
    ds_add_rtn_u32 v173, v157, v31 offset:59388
    s_mov_b64 exec, -1
    v_cmp_ne_u32 vcc, 0, v157
    s_mov_b32 s48, 0x80808080
    s_and_b32 exec_lo, vcc_lo, s48
    s_and_b32 exec_hi, vcc_hi, s48
    s_cbranch_execz K2_X3N1
    s_mov_b32 s48, 3743744
    buffer_load_dword v103, v102, s[12:15], s48 offen
    s_waitcnt vmcnt(0)
    v_or_b32 v104, v104, v103
K2_X3N1:
    s_mov_b64 exec, -1
    v_lshlrev_b32_sdwa v158, 2, v139 dst_sel:DWORD dst_unused:UNUSED_PAD src0_sel:DWORD src1_sel:BYTE_3
    s_cmp_lg_u32 s47, 0
    s_cbranch_scc1 K2_X3K2
    v_cmp_ne_u32 s[92:93], 0, v158
K2_X3K2:
    s_mov_b32 s48, 1048576
    s_mov_b64 exec, s[92:93]
    buffer_load_dword v222, v186, s[12:15], s48 offen
    ds_add_rtn_u32 v174, v158, v31 offset:59388
    s_mov_b64 exec, -1
    v_cmp_ne_u32 vcc, 0, v158
    s_mov_b32 s48, 0x80808080
    s_and_b32 exec_lo, vcc_lo, s48
    s_and_b32 exec_hi, vcc_hi, s48
    s_cbranch_execz K2_X3N2
    s_mov_b32 s48, 5390336
    buffer_load_dword v103, v102, s[12:15], s48 offen
    s_waitcnt vmcnt(0)
    v_or_b32 v104, v104, v103
K2_X3N2:
    s_mov_b64 exec, -1
    v_lshlrev_b32_sdwa v159, 2, v143 dst_sel:DWORD dst_unused:UNUSED_PAD src0_sel:DWORD src1_sel:BYTE_3
    s_cmp_lg_u32 s47, 0
    s_cbranch_scc1 K2_X3K3
    v_cmp_ne_u32 s[94:95], 0, v159
K2_X3K3:
    s_mov_b32 s48, 1572864
    s_mov_b64 exec, s[94:95]
    buffer_load_dword v223, v186, s[12:15], s48 offen
    ds_add_rtn_u32 v175, v159, v31 offset:59388
    s_mov_b64 exec, -1
    v_cmp_ne_u32 vcc, 0, v159
    s_mov_b32 s48, 0x80808080
    s_and_b32 exec_lo, vcc_lo, s48
    s_and_b32 exec_hi, vcc_hi, s48
    s_cbranch_execz K2_X3N3
    s_mov_b32 s48, 7036928
    buffer_load_dword v103, v102, s[12:15], s48 offen
    s_waitcnt vmcnt(0)
    v_or_b32 v104, v104, v103
K2_X3N3:
    s_mov_b64 exec, -1
    v_cmp_ne_u32 vcc, 0, v104
    v_mov_b32 v107, 60704
    s_and_b64 exec, exec, vcc
    ds_write_b32 v107, v107
    s_mov_b64 exec, -1
    s_add_u32 s48, s36, 60528
    v_mad_u32_u24 v204, v156, 52, s48
    v_mad_u32_u24 v205, v157, 52, s48
    v_mad_u32_u24 v206, v158, 52, s48
    v_mad_u32_u24 v207, v159, 52, s48
    s_waitcnt lgkmcnt(0)
    v_min_u32 v172, v204, v172
    v_min_u32 v173, v205, v173
    v_min_u32 v174, v206, v174
    v_min_u32 v175, v207, v175
    s_branch K2_COUNTED
K2_X3PUT:
    s_mov_b64 exec, s[88:89]
    ds_write_b32 v172, v220
    s_mov_b64 exec, s[90:91]
    ds_write_b32 v173, v221
    s_mov_b64 exec, s[92:93]
    ds_write_b32 v174, v222
    s_mov_b64 exec, s[94:95]
    ds_write_b32 v175, v223
    s_mov_b64 exec, -1
    s_branch K2_B4B
K2_SLOWLOAD:
    s_lshl_b32 s48, s3, 10
    s_add_u32 m0, s48, 43008
    s_movk_i32 s49, 16384
    buffer_load_dwordx4 v24, s[16:19], s49 offen lds
    s_add_u32 m0, s48, 26624
    s_movk_i32 s49, 0
    buffer_load_dwordx4 v24, s[16:19], s49 offen lds
    s_add_u32 m0, s48, 34816
    s_movk_i32 s49, 8192
    buffer_load_dwordx4 v24, s[16:19], s49 offen lds
    s_add_u32 m0, s48, 51200
    s_movk_i32 s49, 24576
    buffer_load_dwordx4 v24, s[16:19], s49 offen lds
    s_waitcnt vmcnt(0)
    s_cmp_lg_u32 s45, 0
    s_cbranch_scc1 K2_CHUNK
    v_lshlrev_b32_sdwa v144, 2, v131 dst_sel:DWORD dst_unused:UNUSED_PAD src0_sel:DWORD src1_sel:BYTE_0
    v_lshlrev_b32_sdwa v145, 2, v131 dst_sel:DWORD dst_unused:UNUSED_PAD src0_sel:DWORD src1_sel:BYTE_1
    v_lshlrev_b32_sdwa v146, 2, v131 dst_sel:DWORD dst_unused:UNUSED_PAD src0_sel:DWORD src1_sel:BYTE_2
    v_lshlrev_b32_sdwa v147, 2, v135 dst_sel:DWORD dst_unused:UNUSED_PAD src0_sel:DWORD src1_sel:BYTE_0
    v_lshlrev_b32_sdwa v148, 2, v135 dst_sel:DWORD dst_unused:UNUSED_PAD src0_sel:DWORD src1_sel:BYTE_1
    v_lshlrev_b32_sdwa v149, 2, v135 dst_sel:DWORD dst_unused:UNUSED_PAD src0_sel:DWORD src1_sel:BYTE_2
    v_lshlrev_b32_sdwa v150, 2, v139 dst_sel:DWORD dst_unused:UNUSED_PAD src0_sel:DWORD src1_sel:BYTE_0
    v_lshlrev_b32_sdwa v151, 2, v139 dst_sel:DWORD dst_unused:UNUSED_PAD src0_sel:DWORD src1_sel:BYTE_1
    v_lshlrev_b32_sdwa v152, 2, v139 dst_sel:DWORD dst_unused:UNUSED_PAD src0_sel:DWORD src1_sel:BYTE_2
    v_lshlrev_b32_sdwa v153, 2, v143 dst_sel:DWORD dst_unused:UNUSED_PAD src0_sel:DWORD src1_sel:BYTE_0
    v_lshlrev_b32_sdwa v154, 2, v143 dst_sel:DWORD dst_unused:UNUSED_PAD src0_sel:DWORD src1_sel:BYTE_1
    v_lshlrev_b32_sdwa v155, 2, v143 dst_sel:DWORD dst_unused:UNUSED_PAD src0_sel:DWORD src1_sel:BYTE_2
    s_mov_b64 exec, s[64:65]
    ds_add_rtn_u32 v160, v144, v31 offset:59388
    s_mov_b64 exec, s[66:67]
    ds_add_rtn_u32 v161, v145, v31 offset:59388
    s_mov_b64 exec, s[68:69]
    ds_add_rtn_u32 v162, v146, v31 offset:59388
    s_mov_b64 exec, s[70:71]
    ds_add_rtn_u32 v163, v147, v31 offset:59388
    s_mov_b64 exec, s[72:73]
    ds_add_rtn_u32 v164, v148, v31 offset:59388
    s_mov_b64 exec, s[74:75]
    ds_add_rtn_u32 v165, v149, v31 offset:59388
    s_mov_b64 exec, s[76:77]
    ds_add_rtn_u32 v166, v150, v31 offset:59388
    s_mov_b64 exec, s[78:79]
    ds_add_rtn_u32 v167, v151, v31 offset:59388
    s_mov_b64 exec, s[80:81]
    ds_add_rtn_u32 v168, v152, v31 offset:59388
    s_mov_b64 exec, s[82:83]
    ds_add_rtn_u32 v169, v153, v31 offset:59388
    s_mov_b64 exec, s[84:85]
    ds_add_rtn_u32 v170, v154, v31 offset:59388
    s_mov_b64 exec, s[86:87]
    ds_add_rtn_u32 v171, v155, v31 offset:59388
    s_mov_b64 exec, -1
    s_add_u32 s48, s36, 60528
    v_mad_u32_u24 v192, v144, 52, s48
    v_mad_u32_u24 v193, v145, 52, s48
    v_mad_u32_u24 v194, v146, 52, s48
    v_mad_u32_u24 v195, v147, 52, s48
    v_mad_u32_u24 v196, v148, 52, s48
    v_mad_u32_u24 v197, v149, 52, s48
    v_mad_u32_u24 v198, v150, 52, s48
    v_mad_u32_u24 v199, v151, 52, s48
    v_mad_u32_u24 v200, v152, 52, s48
    v_mad_u32_u24 v201, v153, 52, s48
    v_mad_u32_u24 v202, v154, 52, s48
    v_mad_u32_u24 v203, v155, 52, s48
    s_waitcnt lgkmcnt(0)
    v_min_u32 v160, v192, v160
    v_min_u32 v161, v193, v161
    v_min_u32 v162, v194, v162
    v_min_u32 v163, v195, v163
    v_min_u32 v164, v196, v164
    v_min_u32 v165, v197, v165
    v_min_u32 v166, v198, v166
    v_min_u32 v167, v199, v167
    v_min_u32 v168, v200, v168
    v_min_u32 v169, v201, v169
    v_min_u32 v170, v202, v170
    v_min_u32 v171, v203, v171
    s_mov_b64 exec, s[64:65]
    ds_write_b32 v160, v128
    s_mov_b64 exec, s[66:67]
    ds_write_b32 v161, v129
    s_mov_b64 exec, s[68:69]
    ds_write_b32 v162, v130
    s_mov_b64 exec, s[70:71]
    ds_write_b32 v163, v132
    s_mov_b64 exec, s[72:73]
    ds_write_b32 v164, v133
    s_mov_b64 exec, s[74:75]
    ds_write_b32 v165, v134
    s_mov_b64 exec, s[76:77]
    ds_write_b32 v166, v136
    s_mov_b64 exec, s[78:79]
    ds_write_b32 v167, v137
    s_mov_b64 exec, s[80:81]
    ds_write_b32 v168, v138
    s_mov_b64 exec, s[82:83]
    ds_write_b32 v169, v140
    s_mov_b64 exec, s[84:85]
    ds_write_b32 v170, v141
    s_mov_b64 exec, s[86:87]
    ds_write_b32 v171, v142
    s_mov_b64 exec, -1
    s_branch K2_X3
K2_CHUNK:
    s_sub_u32 s48, s45, 16
    s_lshl_b32 s49, s48, 3
    v_mul_u32_u24 v102, 25728, v22
    v_add_u32 v102, 2097152, v102
    v_lshrrev_b32 v105, 3, v23
    v_add_u32 v105, s48, v105
    v_add_u32 v106, 1, v105
    v_or_b32 v107, 28, v28
    v_mov_b32 v104, 0
    ds_bpermute_b32 v108, v107, v131
    v_mov_b32 v180, 0
    v_add3_u32 v103, v102, v23, s49
    s_waitcnt lgkmcnt(0)
    v_cmp_lt_u32 vcc, 0xffffff, v108
    s_mov_b64 exec, vcc
    buffer_load_dword v180, v102, s[12:15], 0 offen
    buffer_load_dwordx4 v[192:195], v103, s[12:15], 0 offen offset:16
    s_waitcnt vmcnt(0)
    s_mov_b64 exec, -1
    v_max_u32 v104, v104, v180
    v_add_u32 v102, 1646592, v102
    ds_bpermute_b32 v108, v107, v135
    v_mov_b32 v181, 0
    v_add3_u32 v103, v102, v23, s49
    s_waitcnt lgkmcnt(0)
    v_cmp_lt_u32 vcc, 0xffffff, v108
    s_mov_b64 exec, vcc
    buffer_load_dword v181, v102, s[12:15], 0 offen
    buffer_load_dwordx4 v[196:199], v103, s[12:15], 0 offen offset:16
    s_waitcnt vmcnt(0)
    s_mov_b64 exec, -1
    v_max_u32 v104, v104, v181
    v_add_u32 v102, 1646592, v102
    ds_bpermute_b32 v108, v107, v139
    v_mov_b32 v182, 0
    v_add3_u32 v103, v102, v23, s49
    s_waitcnt lgkmcnt(0)
    v_cmp_lt_u32 vcc, 0xffffff, v108
    s_mov_b64 exec, vcc
    buffer_load_dword v182, v102, s[12:15], 0 offen
    buffer_load_dwordx4 v[200:203], v103, s[12:15], 0 offen offset:16
    s_waitcnt vmcnt(0)
    s_mov_b64 exec, -1
    v_max_u32 v104, v104, v182
    v_add_u32 v102, 1646592, v102
    ds_bpermute_b32 v108, v107, v143
    v_mov_b32 v183, 0
    v_add3_u32 v103, v102, v23, s49
    s_waitcnt lgkmcnt(0)
    v_cmp_lt_u32 vcc, 0xffffff, v108
    s_mov_b64 exec, vcc
    buffer_load_dword v183, v102, s[12:15], 0 offen
    buffer_load_dwordx4 v[204:207], v103, s[12:15], 0 offen offset:16
    s_waitcnt vmcnt(0)
    s_mov_b64 exec, -1
    v_max_u32 v104, v104, v183
    v_add_u32 v102, 1646592, v102
    s_cmp_lg_u32 s47, 0
    s_cbranch_scc1 K2_CKEEP
    s_mov_b64 s[68:69], 0
    s_mov_b64 s[88:89], 0
    v_cmp_lt_u32 vcc, v105, v180
    v_cmp_eq_u32_sdwa s[64:65], s2, v193 src0_sel:DWORD src1_sel:WORD_1
    s_and_b64 s[64:65], s[64:65], vcc
    v_cmp_lt_u32 vcc, v106, v180
    v_cmp_eq_u32_sdwa s[66:67], s2, v195 src0_sel:DWORD src1_sel:WORD_1
    s_and_b64 s[66:67], s[66:67], vcc
    s_mov_b64 s[74:75], 0
    s_mov_b64 s[90:91], 0
    v_cmp_lt_u32 vcc, v105, v181
    v_cmp_eq_u32_sdwa s[70:71], s2, v197 src0_sel:DWORD src1_sel:WORD_1
    s_and_b64 s[70:71], s[70:71], vcc
    v_cmp_lt_u32 vcc, v106, v181
    v_cmp_eq_u32_sdwa s[72:73], s2, v199 src0_sel:DWORD src1_sel:WORD_1
    s_and_b64 s[72:73], s[72:73], vcc
    s_mov_b64 s[80:81], 0
    s_mov_b64 s[92:93], 0
    v_cmp_lt_u32 vcc, v105, v182
    v_cmp_eq_u32_sdwa s[76:77], s2, v201 src0_sel:DWORD src1_sel:WORD_1
    s_and_b64 s[76:77], s[76:77], vcc
    v_cmp_lt_u32 vcc, v106, v182
    v_cmp_eq_u32_sdwa s[78:79], s2, v203 src0_sel:DWORD src1_sel:WORD_1
    s_and_b64 s[78:79], s[78:79], vcc
    s_mov_b64 s[86:87], 0
    s_mov_b64 s[94:95], 0
    v_cmp_lt_u32 vcc, v105, v183
    v_cmp_eq_u32_sdwa s[82:83], s2, v205 src0_sel:DWORD src1_sel:WORD_1
    s_and_b64 s[82:83], s[82:83], vcc
    v_cmp_lt_u32 vcc, v106, v183
    v_cmp_eq_u32_sdwa s[84:85], s2, v207 src0_sel:DWORD src1_sel:WORD_1
    s_and_b64 s[84:85], s[84:85], vcc
K2_CKEEP:
    v_mov_b32 v128, v192
    v_and_b32 v144, 0xffff, v193
    v_mov_b32 v129, v194
    v_and_b32 v145, 0xffff, v195
    v_mov_b32 v132, v196
    v_and_b32 v147, 0xffff, v197
    v_mov_b32 v133, v198
    v_and_b32 v148, 0xffff, v199
    v_mov_b32 v136, v200
    v_and_b32 v150, 0xffff, v201
    v_mov_b32 v137, v202
    v_and_b32 v151, 0xffff, v203
    v_mov_b32 v140, v204
    v_and_b32 v153, 0xffff, v205
    v_mov_b32 v141, v206
    v_and_b32 v154, 0xffff, v207
    v_cmp_lt_u32 vcc, s45, v104
    v_mov_b32 v107, 60704
    s_and_b64 exec, exec, vcc
    ds_write_b32 v107, v107
    s_mov_b64 exec, -1
    s_mov_b64 exec, s[64:65]
    ds_add_rtn_u32 v160, v144, v31 offset:59388
    s_mov_b64 exec, s[66:67]
    ds_add_rtn_u32 v161, v145, v31 offset:59388
    s_mov_b64 exec, s[70:71]
    ds_add_rtn_u32 v163, v147, v31 offset:59388
    s_mov_b64 exec, s[72:73]
    ds_add_rtn_u32 v164, v148, v31 offset:59388
    s_mov_b64 exec, s[76:77]
    ds_add_rtn_u32 v166, v150, v31 offset:59388
    s_mov_b64 exec, s[78:79]
    ds_add_rtn_u32 v167, v151, v31 offset:59388
    s_mov_b64 exec, s[82:83]
    ds_add_rtn_u32 v169, v153, v31 offset:59388
    s_mov_b64 exec, s[84:85]
    ds_add_rtn_u32 v170, v154, v31 offset:59388
    s_mov_b64 exec, -1
    s_add_u32 s48, s36, 60528
    v_mad_u32_u24 v192, v144, 52, s48
    v_mad_u32_u24 v193, v145, 52, s48
    v_mad_u32_u24 v195, v147, 52, s48
    v_mad_u32_u24 v196, v148, 52, s48
    v_mad_u32_u24 v198, v150, 52, s48
    v_mad_u32_u24 v199, v151, 52, s48
    v_mad_u32_u24 v201, v153, 52, s48
    v_mad_u32_u24 v202, v154, 52, s48
    s_waitcnt lgkmcnt(0)
    v_min_u32 v160, v192, v160
    v_min_u32 v161, v193, v161
    v_min_u32 v163, v195, v163
    v_min_u32 v164, v196, v164
    v_min_u32 v166, v198, v166
    v_min_u32 v167, v199, v167
    v_min_u32 v169, v201, v169
    v_min_u32 v170, v202, v170
    s_mov_b64 exec, s[64:65]
    ds_write_b32 v160, v128
    s_mov_b64 exec, s[66:67]
    ds_write_b32 v161, v129
    s_mov_b64 exec, s[70:71]
    ds_write_b32 v163, v132
    s_mov_b64 exec, s[72:73]
    ds_write_b32 v164, v133
    s_mov_b64 exec, s[76:77]
    ds_write_b32 v166, v136
    s_mov_b64 exec, s[78:79]
    ds_write_b32 v167, v137
    s_mov_b64 exec, s[82:83]
    ds_write_b32 v169, v140
    s_mov_b64 exec, s[84:85]
    ds_write_b32 v170, v141
    s_mov_b64 exec, -1
    s_branch K2_COUNTED
K2_LOADACC:
    s_lshl_b32 s48, s43, 7
    s_sub_u32 s48, s48, 128
    v_add_u32 v192, s48, v9
    ds_read_b32 v192, v192
    v_mbcnt_lo_u32_b32 v193, -1, 0
    v_mbcnt_hi_u32_b32 v193, -1, v193
    s_cmp_ge_u32 s44, 3
    s_cselect_b32 s48, 0, 8
    s_cmp_eq_u32 s44, 0
    s_cselect_b32 s48, 12, s48
    v_and_b32 v194, s48, v193
    v_cmp_eq_u32 vcc, 0, v194
    v_mov_b32 v195, 0xffff
    v_lshrrev_b32 v193, 5, v193
    v_lshlrev_b32 v193, 8, v193
    s_waitcnt lgkmcnt(0)
    v_cndmask_b32 v192, v195, v192, vcc
    v_lshl_add_u32 v192, v192, 9, v193
    buffer_load_dwordx4 v[128:131], v192, s[24:27], 0 offen offset:0
    buffer_load_dwordx4 v[132:135], v192, s[24:27], 0 offen offset:16
    buffer_load_dwordx4 v[136:139], v192, s[24:27], 0 offen offset:32
    buffer_load_dwordx4 v[140:143], v192, s[24:27], 0 offen offset:48
    buffer_load_dwordx4 v[144:147], v192, s[24:27], 0 offen offset:64
    buffer_load_dwordx4 v[148:151], v192, s[24:27], 0 offen offset:80
    buffer_load_dwordx4 v[152:155], v192, s[24:27], 0 offen offset:96
    buffer_load_dwordx4 v[156:159], v192, s[24:27], 0 offen offset:112
    buffer_load_dwordx4 v[160:163], v192, s[24:27], 0 offen offset:128
    buffer_load_dwordx4 v[164:167], v192, s[24:27], 0 offen offset:144
    buffer_load_dwordx4 v[168:171], v192, s[24:27], 0 offen offset:160
    buffer_load_dwordx4 v[172:175], v192, s[24:27], 0 offen offset:176
    buffer_load_dwordx4 v[176:179], v192, s[24:27], 0 offen offset:192
    buffer_load_dwordx4 v[180:183], v192, s[24:27], 0 offen offset:208
    buffer_load_dwordx4 v[184:187], v192, s[24:27], 0 offen offset:224
    buffer_load_dwordx4 v[188:191], v192, s[24:27], 0 offen offset:240
    s_waitcnt vmcnt(0)
    s_branch K2_ACCDONE
K2_STOREACC:
    v_lshlrev_b32 v4, 8, v4
    v_lshl_add_u32 v4, v6, 9, v4
    buffer_store_dwordx4 v[128:131], v4, s[24:27], 0 offen offset:0
    buffer_store_dwordx4 v[132:135], v4, s[24:27], 0 offen offset:16
    buffer_store_dwordx4 v[136:139], v4, s[24:27], 0 offen offset:32
    buffer_store_dwordx4 v[140:143], v4, s[24:27], 0 offen offset:48
    buffer_store_dwordx4 v[144:147], v4, s[24:27], 0 offen offset:64
    buffer_store_dwordx4 v[148:151], v4, s[24:27], 0 offen offset:80
    buffer_store_dwordx4 v[152:155], v4, s[24:27], 0 offen offset:96
    buffer_store_dwordx4 v[156:159], v4, s[24:27], 0 offen offset:112
    buffer_store_dwordx4 v[160:163], v4, s[24:27], 0 offen offset:128
    buffer_store_dwordx4 v[164:167], v4, s[24:27], 0 offen offset:144
    buffer_store_dwordx4 v[168:171], v4, s[24:27], 0 offen offset:160
    buffer_store_dwordx4 v[172:175], v4, s[24:27], 0 offen offset:176
    buffer_store_dwordx4 v[176:179], v4, s[24:27], 0 offen offset:192
    buffer_store_dwordx4 v[180:183], v4, s[24:27], 0 offen offset:208
    buffer_store_dwordx4 v[184:187], v4, s[24:27], 0 offen offset:224
    buffer_store_dwordx4 v[188:191], v4, s[24:27], 0 offen offset:240
    s_mov_b32 s46, 1
    s_cmp_lg_u32 s47, 0
    s_cselect_b32 s48, 0, 16
    s_add_u32 s45, s45, s48
K2_AGAIN:
    s_waitcnt vmcnt(0) lgkmcnt(0)
    s_barrier
    v_mbcnt_lo_u32_b32 v20, -1, 0
    v_mbcnt_hi_u32_b32 v20, -1, v20
    s_lshl_b32 s48, s3, 6
    v_add_u32 v21, s48, v20
    v_lshrrev_b32 v22, 3, v21
    v_and_b32 v23, 7, v20
    v_lshlrev_b32 v23, 4, v23
    s_lshl_b32 s49, s2, 7
    v_lshl_add_u32 v176, v22, 15, s49
    v_add_u32 v176, v176, v23
    v_add_u32 v177, 2097152, v176
    v_add_u32 v178, 4194304, v176
    v_add_u32 v179, 6291456, v176
    buffer_load_dwordx4 v[128:131], v176, s[8:11], 0 offen nt
    buffer_load_dwordx4 v[132:135], v177, s[8:11], 0 offen nt
    s_branch K2_RESTART
.section .rodata,"a"

.p2align 6
.amdhsa_kernel part_kernel
  .amdhsa_next_free_vgpr 52
  .amdhsa_next_free_sgpr 24
  .amdhsa_accum_offset 52
  .amdhsa_group_segment_fixed_size 0
  .amdhsa_kernarg_size 96
  .amdhsa_user_sgpr_count 2
  .amdhsa_user_sgpr_kernarg_segment_ptr 1
  .amdhsa_system_sgpr_workgroup_id_x 1
  .amdhsa_float_denorm_mode_32 3
.end_amdhsa_kernel

.p2align 6
.amdhsa_kernel main_kernel
  .amdhsa_next_free_vgpr 256
  .amdhsa_next_free_sgpr 96
  .amdhsa_accum_offset 256
  .amdhsa_group_segment_fixed_size 0
  .amdhsa_kernarg_size 96
  .amdhsa_user_sgpr_count 2
  .amdhsa_user_sgpr_kernarg_segment_ptr 1
  .amdhsa_system_sgpr_workgroup_id_x 1
  .amdhsa_float_denorm_mode_32 3
.end_amdhsa_kernel
```
